```python
import torch

def _softmax(x, axis=-1):
    return torch.softmax(x, dim=axis)
def _gelu(x):
    return torch.nn.functional.gelu(x, approximate="tanh")
def _silu(x):
    return torch.nn.functional.silu(x)
def _sigmoid(x):
    return torch.sigmoid(x)
def _layernorm(x, axis=-1, eps=1e-5):
    m = x.mean(dim=axis, keepdim=True)
    v = x.var(dim=axis, keepdim=True, unbiased=False)
    return (x - m) / torch.sqrt(v + eps)
def _scatter_add(tgt, idx, src, axis=0):
    return tgt.clone().index_add_(axis, idx, src)
def _segment_sum(src, seg, n):
    out = torch.zeros((n,) + src.shape[1:], dtype=src.dtype)
    return out.index_add_(0, seg, src)
def _pad(x, pw):
    flat = tuple(v for pair in reversed(pw) for v in pair)
    return torch.nn.functional.pad(x, flat)

kernel_name = 'interleave_layers__ssm_conv_s4__swiglu_ffn__prompt'

def setup_inputs():

    _w = (lambda a: (lambda t: t.to(torch.bfloat16) if t.is_floating_point() else t)(torch.as_tensor(a)))
    def _A_setup():
        B, L, D, N = 1, 2048, 512, 128
        A_re = -(lambda _x: torch.exp(torch.as_tensor(_x)))((lambda *s: torch.randn(*s, dtype=torch.bfloat16) * 1.6)(D, N))
        A_im = torch.pi * (lambda *s: torch.randn(*s, dtype=torch.bfloat16) * 0.2)(D, N)
        B_re = (lambda *s: torch.randn(*s, dtype=torch.bfloat16) * 0.2)(D, N)
        B_im = (lambda *s: torch.randn(*s, dtype=torch.bfloat16) * 0.2)(D, N)
        C_re = (lambda *s: torch.randn(*s, dtype=torch.bfloat16) * 0.2)(D, N)
        C_im = (lambda *s: torch.randn(*s, dtype=torch.bfloat16) * 0.2)(D, N)
        log_dt = (lambda *s: torch.randn(*s, dtype=torch.bfloat16) * 0.2)(D) * 0.5 - 4.0
        Dskip = (lambda *s: torch.randn(*s, dtype=torch.bfloat16) * 0.2)(D)
        return {
            "u": _w((lambda *s: torch.randn(*s, dtype=torch.bfloat16) * 0.05)(B, L, D)),
            "A_re": _w(A_re),
            "A_im": _w(A_im),
            "B_re": _w(B_re),
            "B_im": _w(B_im),
            "C_re": _w(C_re),
            "C_im": _w(C_im),
            "log_dt": _w(log_dt),
            "Dskip": _w(Dskip),
        }
    _A_in = _A_setup()

    def _B_setup():
        B, S, D, F = 1, 2048, 512, 1376
        return {
            "x": _w((lambda *s: torch.randn(*s, dtype=torch.bfloat16) * 0.05)(B, S, D)),
            "w_gate": _w((lambda *s: torch.randn(*s, dtype=torch.bfloat16) * 0.05)(D, F)),
            "w_up": _w((lambda *s: torch.randn(*s, dtype=torch.bfloat16) * 0.05)(D, F)),
            "w_down": _w((lambda *s: torch.randn(*s, dtype=torch.bfloat16) * 0.05)(F, D)),
        }
    _B_in = _B_setup()

    return {
        "A_u": _A_in["u"],
        "A_A_re": _A_in["A_re"],
        "A_A_im": _A_in["A_im"],
        "A_B_re": _A_in["B_re"],
        "A_B_im": _A_in["B_im"],
        "A_C_re": _A_in["C_re"],
        "A_C_im": _A_in["C_im"],
        "A_log_dt": _A_in["log_dt"],
        "A_Dskip": _A_in["Dskip"],
        "B_x": _B_in["x"],
        "B_w_gate": _B_in["w_gate"],
        "B_w_up": _B_in["w_up"],
        "B_w_down": _B_in["w_down"],
    }

def reference(A_u, A_A_re, A_A_im, A_B_re, A_B_im, A_C_re, A_C_im, A_log_dt, A_Dskip, B_x, B_w_gate, B_w_up, B_w_down):
    def _A_ref(u, A_re, A_im, B_re, B_im, C_re, C_im, log_dt, Dskip):
        Bsz, L, D = u.shape
        dt = torch.exp(log_dt)[:, None]
        A = A_re + 1j * A_im
        Bc = B_re + 1j * B_im
        Cc = C_re + 1j * C_im
        logdA = dt * A
        dB = dt * Bc
        l = (lambda x, dt: x.to(dt))(torch.arange(L), A_re.dtype)
        P = torch.exp(logdA[:, :, None] * l[None, None, :])
        K = torch.einsum("dn,dnl,dn->dl", Cc, P, dB).real
        L2 = 2 * L
        Kp = _pad(K, ((0, 0), (0, L)))
        up = (lambda x, *d: x.permute(*d))(u, 0, 2, 1)
        up = _pad(up, ((0, 0), (0, 0), (0, L)))
        Kf = (lambda x, axes=(-2,-1): torch.fft.rfft2(x.float(), dim=axes))(Kp[:, None, :], axes=(-2, -1))
        Uf = (lambda x, axes=(-2,-1): torch.fft.rfft2(x.float(), dim=axes))(up[:, :, None, :], axes=(-2, -1))
        Yf = Uf * Kf[None, :, :, :]
        y = (lambda x, s, axes=(-2,-1): torch.fft.irfft2(x, s=s, dim=axes).to(torch.bfloat16))(Yf, (1, L2), axes=(-2, -1))[:, :, 0, :L]
        y = (lambda x, *d: x.permute(*d))(y, 0, 2, 1) + u * Dskip[None, None, :]
        return y

    def _B_ref(x, w_gate, w_up, w_down):
        g = _silu(x @ w_gate)
        u = x @ w_up
        return (g * u) @ w_down

    x = A_u
    x = x + _A_ref(_layernorm(x, axis=-1), A_A_re, A_A_im, A_B_re, A_B_im, A_C_re, A_C_im, A_log_dt, A_Dskip)
    x = x + _B_ref(_layernorm(x, axis=-1), B_w_gate, B_w_up, B_w_down)
    x = x + _A_ref(_layernorm(x, axis=-1), A_A_re, A_A_im, A_B_re, A_B_im, A_C_re, A_C_im, A_log_dt, A_Dskip)
    x = x + _B_ref(_layernorm(x, axis=-1), B_w_gate, B_w_up, B_w_down)
    return x
```

```asm
; @launch kernel=front_kernel grid=(768,1,1) block=(256,1,1) lds=42752
; @launch kernel=ffn1_kernel grid=(256,1,1) block=(512,1,1) lds=163840
; @launch kernel=conv2_kernel grid=(512,1,1) block=(256,1,1) lds=42752
; @launch kernel=ffn2_kernel grid=(256,1,1) block=(512,1,1) lds=163840
.amdgcn_target "amdgcn-amd-amdhsa--gfx950"
.text
.globl front_kernel
.p2align 8
.type front_kernel,@function
front_kernel:
    s_load_dwordx16 s[16:31], s[0:1], 0
    s_load_dwordx8 s[32:39], s[0:1], 80
    s_load_dwordx2 s[40:41], s[0:1], 120
    s_load_dwordx2 s[60:61], s[0:1], 64
    s_load_dwordx2 s[62:63], s[0:1], 112
    s_cmp_ge_u32 s2, 768
    s_cbranch_scc1 front_done
    s_cmp_lt_u32 s2, 256
    s_cbranch_scc1 front_roles
    s_sub_u32 s2, s2, 256
    s_lshl_b32 s3, s2, 8
    v_and_b32 v1, 0xf0, v0
    v_add_u32 v1, s3, v1
    s_lshr_b32 s4, s2, 1
    s_lshl_b32 s4, s4, 2
    v_readfirstlane_b32 s64, v0
    s_nop 0
    s_lshr_b32 s64, s64, 6
    s_waitcnt lgkmcnt(0)
    s_load_dword s5, s[30:31], s4
    s_load_dword s65, s[60:61], s4
    global_load_dwordx4 v[8:11], v1, s[18:19]
    global_load_dwordx4 v[12:15], v1, s[20:21]
    global_load_dwordx4 v[16:19], v1, s[22:23]
    global_load_dwordx4 v[20:23], v1, s[24:25]
    global_load_dwordx4 v[24:27], v1, s[26:27]
    global_load_dwordx4 v[28:31], v1, s[28:29]
    s_mov_b32 s44, s40
    s_mov_b32 s45, s41
    s_mov_b32 s46, 0x280000
    s_mov_b32 s47, 0x00020000
    v_and_b32 v2, 15, v0
    v_lshrrev_b32 v3, 3, v2
    v_and_b32 v4, 7, v2
    v_lshl_add_u32 v56, v3, 7, v4
    v_lshrrev_b32 v5, 2, v2
    v_and_b32 v6, 3, v2
    v_lshlrev_b32 v6, 1, v6
    v_lshl_add_u32 v5, v5, 7, v6
    v_add_u32 v5, 256, v5
    v_lshrrev_b32 v6, 1, v4
    v_and_b32 v7, 1, v2
    v_lshlrev_b32 v7, 2, v7
    v_lshl_add_u32 v6, v6, 7, v7
    v_add_u32 v6, 512, v6
    v_cmp_gt_u32 vcc, 8, v2
    s_nop 1
    v_cndmask_b32 v57, v6, v5, vcc
    v_min_u32 v5, 8, v2
    v_lshlrev_b32 v5, 7, v5
    v_add_u32 v58, 0x400, v5
    v_lshlrev_b32 v59, 3, v2
    v_cvt_f32_u32 v56, v56
    v_cvt_f32_u32 v57, v57
    v_cvt_f32_u32 v58, v58
    v_cvt_f32_u32 v59, v59
    v_lshlrev_b32 v3, 3, v0
    v_sub_u32 v112, 2072, v3
    v_cvt_f32_u32 v120, v112
    v_sub_u32 v113, 2071, v3
    v_cvt_f32_u32 v121, v113
    v_sub_u32 v114, 2070, v3
    v_cvt_f32_u32 v122, v114
    v_sub_u32 v115, 2069, v3
    v_cvt_f32_u32 v123, v115
    v_sub_u32 v116, 2068, v3
    v_cvt_f32_u32 v124, v116
    v_sub_u32 v117, 2067, v3
    v_cvt_f32_u32 v125, v117
    v_sub_u32 v118, 2066, v3
    v_cvt_f32_u32 v126, v118
    v_sub_u32 v119, 2065, v3
    v_cvt_f32_u32 v127, v119
    v_cvt_pk_bf16_f32 v128, v120, v121
    v_lshlrev_b32 v120, 16, v128
    v_and_b32 v121, 0xffff0000, v128
    v_cvt_pk_bf16_f32 v128, v122, v123
    v_lshlrev_b32 v122, 16, v128
    v_and_b32 v123, 0xffff0000, v128
    v_cvt_pk_bf16_f32 v128, v124, v125
    v_lshlrev_b32 v124, 16, v128
    v_and_b32 v125, 0xffff0000, v128
    v_cvt_pk_bf16_f32 v128, v126, v127
    v_lshlrev_b32 v126, 16, v128
    v_and_b32 v127, 0xffff0000, v128
    v_cvt_u32_f32 v120, v120
    v_or_b32 v128, 1, v120
    v_ffbh_u32 v128, v128
    v_sub_u32 v128, 24, v128
    v_med3_i32 v128, v128, 0, 3
    v_lshrrev_b32 v129, 7, v120
    v_sub_u32 v130, 3, v128
    v_lshlrev_b32 v129, v130, v129
    v_and_b32 v130, 7, v120
    v_lshrrev_b32 v130, v128, v130
    v_lshl_add_u32 v129, v128, 3, v129
    v_add_u32 v129, v129, v130
    v_bfe_u32 v130, v120, 3, 4
    v_lshl_add_u32 v129, v129, 4, v130
    v_cmp_gt_u32 vcc, 0x800, v112
    v_mov_b32 v130, 768
    s_nop 0
    v_cndmask_b32 v129, v130, v129, vcc
    v_lshlrev_b32 v104, 2, v129
    v_cvt_u32_f32 v121, v121
    v_or_b32 v128, 1, v121
    v_ffbh_u32 v128, v128
    v_sub_u32 v128, 24, v128
    v_med3_i32 v128, v128, 0, 3
    v_lshrrev_b32 v129, 7, v121
    v_sub_u32 v130, 3, v128
    v_lshlrev_b32 v129, v130, v129
    v_and_b32 v130, 7, v121
    v_lshrrev_b32 v130, v128, v130
    v_lshl_add_u32 v129, v128, 3, v129
    v_add_u32 v129, v129, v130
    v_bfe_u32 v130, v121, 3, 4
    v_lshl_add_u32 v129, v129, 4, v130
    v_cmp_gt_u32 vcc, 0x800, v113
    v_mov_b32 v130, 768
    s_nop 0
    v_cndmask_b32 v129, v130, v129, vcc
    v_lshl_or_b32 v104, v129, 18, v104
    v_cvt_u32_f32 v122, v122
    v_or_b32 v128, 1, v122
    v_ffbh_u32 v128, v128
    v_sub_u32 v128, 24, v128
    v_med3_i32 v128, v128, 0, 3
    v_lshrrev_b32 v129, 7, v122
    v_sub_u32 v130, 3, v128
    v_lshlrev_b32 v129, v130, v129
    v_and_b32 v130, 7, v122
    v_lshrrev_b32 v130, v128, v130
    v_lshl_add_u32 v129, v128, 3, v129
    v_add_u32 v129, v129, v130
    v_bfe_u32 v130, v122, 3, 4
    v_lshl_add_u32 v129, v129, 4, v130
    v_cmp_gt_u32 vcc, 0x800, v114
    v_mov_b32 v130, 768
    s_nop 0
    v_cndmask_b32 v129, v130, v129, vcc
    v_lshlrev_b32 v105, 2, v129
    v_cvt_u32_f32 v123, v123
    v_or_b32 v128, 1, v123
    v_ffbh_u32 v128, v128
    v_sub_u32 v128, 24, v128
    v_med3_i32 v128, v128, 0, 3
    v_lshrrev_b32 v129, 7, v123
    v_sub_u32 v130, 3, v128
    v_lshlrev_b32 v129, v130, v129
    v_and_b32 v130, 7, v123
    v_lshrrev_b32 v130, v128, v130
    v_lshl_add_u32 v129, v128, 3, v129
    v_add_u32 v129, v129, v130
    v_bfe_u32 v130, v123, 3, 4
    v_lshl_add_u32 v129, v129, 4, v130
    v_cmp_gt_u32 vcc, 0x800, v115
    v_mov_b32 v130, 768
    s_nop 0
    v_cndmask_b32 v129, v130, v129, vcc
    v_lshl_or_b32 v105, v129, 18, v105
    v_cvt_u32_f32 v124, v124
    v_or_b32 v128, 1, v124
    v_ffbh_u32 v128, v128
    v_sub_u32 v128, 24, v128
    v_med3_i32 v128, v128, 0, 3
    v_lshrrev_b32 v129, 7, v124
    v_sub_u32 v130, 3, v128
    v_lshlrev_b32 v129, v130, v129
    v_and_b32 v130, 7, v124
    v_lshrrev_b32 v130, v128, v130
    v_lshl_add_u32 v129, v128, 3, v129
    v_add_u32 v129, v129, v130
    v_bfe_u32 v130, v124, 3, 4
    v_lshl_add_u32 v129, v129, 4, v130
    v_cmp_gt_u32 vcc, 0x800, v116
    v_mov_b32 v130, 768
    s_nop 0
    v_cndmask_b32 v129, v130, v129, vcc
    v_lshlrev_b32 v106, 2, v129
    v_cvt_u32_f32 v125, v125
    v_or_b32 v128, 1, v125
    v_ffbh_u32 v128, v128
    v_sub_u32 v128, 24, v128
    v_med3_i32 v128, v128, 0, 3
    v_lshrrev_b32 v129, 7, v125
    v_sub_u32 v130, 3, v128
    v_lshlrev_b32 v129, v130, v129
    v_and_b32 v130, 7, v125
    v_lshrrev_b32 v130, v128, v130
    v_lshl_add_u32 v129, v128, 3, v129
    v_add_u32 v129, v129, v130
    v_bfe_u32 v130, v125, 3, 4
    v_lshl_add_u32 v129, v129, 4, v130
    v_cmp_gt_u32 vcc, 0x800, v117
    v_mov_b32 v130, 768
    s_nop 0
    v_cndmask_b32 v129, v130, v129, vcc
    v_lshl_or_b32 v106, v129, 18, v106
    v_cvt_u32_f32 v126, v126
    v_or_b32 v128, 1, v126
    v_ffbh_u32 v128, v128
    v_sub_u32 v128, 24, v128
    v_med3_i32 v128, v128, 0, 3
    v_lshrrev_b32 v129, 7, v126
    v_sub_u32 v130, 3, v128
    v_lshlrev_b32 v129, v130, v129
    v_and_b32 v130, 7, v126
    v_lshrrev_b32 v130, v128, v130
    v_lshl_add_u32 v129, v128, 3, v129
    v_add_u32 v129, v129, v130
    v_bfe_u32 v130, v126, 3, 4
    v_lshl_add_u32 v129, v129, 4, v130
    v_cmp_gt_u32 vcc, 0x800, v118
    v_mov_b32 v130, 768
    s_nop 0
    v_cndmask_b32 v129, v130, v129, vcc
    v_lshlrev_b32 v107, 2, v129
    v_cvt_u32_f32 v127, v127
    v_or_b32 v128, 1, v127
    v_ffbh_u32 v128, v128
    v_sub_u32 v128, 24, v128
    v_med3_i32 v128, v128, 0, 3
    v_lshrrev_b32 v129, 7, v127
    v_sub_u32 v130, 3, v128
    v_lshlrev_b32 v129, v130, v129
    v_and_b32 v130, 7, v127
    v_lshrrev_b32 v130, v128, v130
    v_lshl_add_u32 v129, v128, 3, v129
    v_add_u32 v129, v129, v130
    v_bfe_u32 v130, v127, 3, 4
    v_lshl_add_u32 v129, v129, 4, v130
    v_cmp_gt_u32 vcc, 0x800, v119
    v_mov_b32 v130, 768
    s_nop 0
    v_cndmask_b32 v129, v130, v129, vcc
    v_lshl_or_b32 v107, v129, 18, v107
    s_cmp_lg_u32 s64, 0
    s_cbranch_scc1 front_noidx2
    v_lshlrev_b32 v3, 3, v0
    v_sub_u32 v112, 24, v3
    v_cvt_f32_u32 v120, v112
    v_sub_u32 v113, 23, v3
    v_cvt_f32_u32 v121, v113
    v_sub_u32 v114, 22, v3
    v_cvt_f32_u32 v122, v114
    v_sub_u32 v115, 21, v3
    v_cvt_f32_u32 v123, v115
    v_sub_u32 v116, 20, v3
    v_cvt_f32_u32 v124, v116
    v_sub_u32 v117, 19, v3
    v_cvt_f32_u32 v125, v117
    v_sub_u32 v118, 18, v3
    v_cvt_f32_u32 v126, v118
    v_sub_u32 v119, 17, v3
    v_cvt_f32_u32 v127, v119
    v_cvt_pk_bf16_f32 v128, v120, v121
    v_lshlrev_b32 v120, 16, v128
    v_and_b32 v121, 0xffff0000, v128
    v_cvt_pk_bf16_f32 v128, v122, v123
    v_lshlrev_b32 v122, 16, v128
    v_and_b32 v123, 0xffff0000, v128
    v_cvt_pk_bf16_f32 v128, v124, v125
    v_lshlrev_b32 v124, 16, v128
    v_and_b32 v125, 0xffff0000, v128
    v_cvt_pk_bf16_f32 v128, v126, v127
    v_lshlrev_b32 v126, 16, v128
    v_and_b32 v127, 0xffff0000, v128
    v_cvt_u32_f32 v120, v120
    v_or_b32 v128, 1, v120
    v_ffbh_u32 v128, v128
    v_sub_u32 v128, 24, v128
    v_med3_i32 v128, v128, 0, 3
    v_lshrrev_b32 v129, 7, v120
    v_sub_u32 v130, 3, v128
    v_lshlrev_b32 v129, v130, v129
    v_and_b32 v130, 7, v120
    v_lshrrev_b32 v130, v128, v130
    v_lshl_add_u32 v129, v128, 3, v129
    v_add_u32 v129, v129, v130
    v_bfe_u32 v130, v120, 3, 4
    v_lshl_add_u32 v129, v129, 4, v130
    v_cmp_gt_u32 vcc, 0x800, v112
    v_mov_b32 v130, 768
    s_nop 0
    v_cndmask_b32 v129, v130, v129, vcc
    v_lshlrev_b32 v108, 2, v129
    v_cvt_u32_f32 v121, v121
    v_or_b32 v128, 1, v121
    v_ffbh_u32 v128, v128
    v_sub_u32 v128, 24, v128
    v_med3_i32 v128, v128, 0, 3
    v_lshrrev_b32 v129, 7, v121
    v_sub_u32 v130, 3, v128
    v_lshlrev_b32 v129, v130, v129
    v_and_b32 v130, 7, v121
    v_lshrrev_b32 v130, v128, v130
    v_lshl_add_u32 v129, v128, 3, v129
    v_add_u32 v129, v129, v130
    v_bfe_u32 v130, v121, 3, 4
    v_lshl_add_u32 v129, v129, 4, v130
    v_cmp_gt_u32 vcc, 0x800, v113
    v_mov_b32 v130, 768
    s_nop 0
    v_cndmask_b32 v129, v130, v129, vcc
    v_lshl_or_b32 v108, v129, 18, v108
    v_cvt_u32_f32 v122, v122
    v_or_b32 v128, 1, v122
    v_ffbh_u32 v128, v128
    v_sub_u32 v128, 24, v128
    v_med3_i32 v128, v128, 0, 3
    v_lshrrev_b32 v129, 7, v122
    v_sub_u32 v130, 3, v128
    v_lshlrev_b32 v129, v130, v129
    v_and_b32 v130, 7, v122
    v_lshrrev_b32 v130, v128, v130
    v_lshl_add_u32 v129, v128, 3, v129
    v_add_u32 v129, v129, v130
    v_bfe_u32 v130, v122, 3, 4
    v_lshl_add_u32 v129, v129, 4, v130
    v_cmp_gt_u32 vcc, 0x800, v114
    v_mov_b32 v130, 768
    s_nop 0
    v_cndmask_b32 v129, v130, v129, vcc
    v_lshlrev_b32 v109, 2, v129
    v_cvt_u32_f32 v123, v123
    v_or_b32 v128, 1, v123
    v_ffbh_u32 v128, v128
    v_sub_u32 v128, 24, v128
    v_med3_i32 v128, v128, 0, 3
    v_lshrrev_b32 v129, 7, v123
    v_sub_u32 v130, 3, v128
    v_lshlrev_b32 v129, v130, v129
    v_and_b32 v130, 7, v123
    v_lshrrev_b32 v130, v128, v130
    v_lshl_add_u32 v129, v128, 3, v129
    v_add_u32 v129, v129, v130
    v_bfe_u32 v130, v123, 3, 4
    v_lshl_add_u32 v129, v129, 4, v130
    v_cmp_gt_u32 vcc, 0x800, v115
    v_mov_b32 v130, 768
    s_nop 0
    v_cndmask_b32 v129, v130, v129, vcc
    v_lshl_or_b32 v109, v129, 18, v109
    v_cvt_u32_f32 v124, v124
    v_or_b32 v128, 1, v124
    v_ffbh_u32 v128, v128
    v_sub_u32 v128, 24, v128
    v_med3_i32 v128, v128, 0, 3
    v_lshrrev_b32 v129, 7, v124
    v_sub_u32 v130, 3, v128
    v_lshlrev_b32 v129, v130, v129
    v_and_b32 v130, 7, v124
    v_lshrrev_b32 v130, v128, v130
    v_lshl_add_u32 v129, v128, 3, v129
    v_add_u32 v129, v129, v130
    v_bfe_u32 v130, v124, 3, 4
    v_lshl_add_u32 v129, v129, 4, v130
    v_cmp_gt_u32 vcc, 0x800, v116
    v_mov_b32 v130, 768
    s_nop 0
    v_cndmask_b32 v129, v130, v129, vcc
    v_lshlrev_b32 v110, 2, v129
    v_cvt_u32_f32 v125, v125
    v_or_b32 v128, 1, v125
    v_ffbh_u32 v128, v128
    v_sub_u32 v128, 24, v128
    v_med3_i32 v128, v128, 0, 3
    v_lshrrev_b32 v129, 7, v125
    v_sub_u32 v130, 3, v128
    v_lshlrev_b32 v129, v130, v129
    v_and_b32 v130, 7, v125
    v_lshrrev_b32 v130, v128, v130
    v_lshl_add_u32 v129, v128, 3, v129
    v_add_u32 v129, v129, v130
    v_bfe_u32 v130, v125, 3, 4
    v_lshl_add_u32 v129, v129, 4, v130
    v_cmp_gt_u32 vcc, 0x800, v117
    v_mov_b32 v130, 768
    s_nop 0
    v_cndmask_b32 v129, v130, v129, vcc
    v_lshl_or_b32 v110, v129, 18, v110
    v_cvt_u32_f32 v126, v126
    v_or_b32 v128, 1, v126
    v_ffbh_u32 v128, v128
    v_sub_u32 v128, 24, v128
    v_med3_i32 v128, v128, 0, 3
    v_lshrrev_b32 v129, 7, v126
    v_sub_u32 v130, 3, v128
    v_lshlrev_b32 v129, v130, v129
    v_and_b32 v130, 7, v126
    v_lshrrev_b32 v130, v128, v130
    v_lshl_add_u32 v129, v128, 3, v129
    v_add_u32 v129, v129, v130
    v_bfe_u32 v130, v126, 3, 4
    v_lshl_add_u32 v129, v129, 4, v130
    v_cmp_gt_u32 vcc, 0x800, v118
    v_mov_b32 v130, 768
    s_nop 0
    v_cndmask_b32 v129, v130, v129, vcc
    v_lshlrev_b32 v111, 2, v129
    v_cvt_u32_f32 v127, v127
    v_or_b32 v128, 1, v127
    v_ffbh_u32 v128, v128
    v_sub_u32 v128, 24, v128
    v_med3_i32 v128, v128, 0, 3
    v_lshrrev_b32 v129, 7, v127
    v_sub_u32 v130, 3, v128
    v_lshlrev_b32 v129, v130, v129
    v_and_b32 v130, 7, v127
    v_lshrrev_b32 v130, v128, v130
    v_lshl_add_u32 v129, v128, 3, v129
    v_add_u32 v129, v129, v130
    v_bfe_u32 v130, v127, 3, 4
    v_lshl_add_u32 v129, v129, 4, v130
    v_cmp_gt_u32 vcc, 0x800, v119
    v_mov_b32 v130, 768
    s_nop 0
    v_cndmask_b32 v129, v130, v129, vcc
    v_lshl_or_b32 v111, v129, 18, v111
front_noidx2:
    s_nop 1
    s_waitcnt lgkmcnt(0)
    s_and_b32 s6, s2, 1
    s_lshl_b32 s6, s6, 4
    s_lshr_b32 s5, s5, s6
    s_lshl_b32 s5, s5, 16
    v_mov_b32 v76, s5
    v_mul_f32 v77, 0x3fb8aa3b, v76
    v_mov_b32 v78, 0x3fb8aa3b
    v_fma_f32 v78, v76, v78, -v77
    v_fmac_f32 v78, 0x32a57060, v76
    v_exp_f32 v79, v77
    v_mul_f32 v78, 0x3f317218, v78
    v_fma_f32 v79, v79, v78, v79
    v_cvt_pk_bf16_f32 v79, v79, v79
    v_lshlrev_b32 v60, 16, v79
    v_mov_b32 v61, v60
    s_mov_b32 s6, 0x3fb8aa3b
    s_mov_b32 s7, 0x3e22f983
    s_waitcnt vmcnt(0)
    v_lshlrev_b32 v76, 16, v8
    v_lshlrev_b32 v77, 16, v12
    v_lshlrev_b32 v78, 16, v16
    v_lshlrev_b32 v79, 16, v20
    v_lshlrev_b32 v80, 16, v24
    v_lshlrev_b32 v81, 16, v28
    v_pk_mul_f32 v[62:63], v[76:77], v[60:61]
    v_pk_mul_f32 v[78:79], v[78:79], v[60:61]
    v_pk_mul_f32 v[62:63], v[62:63], s[6:7]
    v_pk_mul_f32 v[64:65], v[78:79], v[80:81] op_sel_hi:[1,0]
    v_pk_fma_f32 v[64:65], v[78:79], v[80:81], v[64:65] op_sel:[1,1,0] op_sel_hi:[0,1,1] neg_lo:[1,0,0]
    v_pk_mul_f32 v[76:77], v[62:63], v[56:57] op_sel_hi:[1,0]
    v_pk_mul_f32 v[80:81], v[62:63], v[56:57] op_sel:[0,1] op_sel_hi:[1,1]
    v_pk_mul_f32 v[84:85], v[62:63], v[58:59] op_sel_hi:[1,0]
    v_pk_mul_f32 v[88:89], v[62:63], v[58:59] op_sel:[0,1] op_sel_hi:[1,1]
    v_fract_f32 v77, v77
    v_fract_f32 v81, v81
    v_fract_f32 v85, v85
    v_fract_f32 v89, v89
    v_exp_f32 v76, v76
    v_cos_f32 v78, v77
    v_sin_f32 v79, v77
    v_exp_f32 v80, v80
    v_cos_f32 v82, v81
    v_sin_f32 v83, v81
    v_exp_f32 v84, v84
    v_cos_f32 v86, v85
    v_sin_f32 v87, v85
    v_exp_f32 v88, v88
    v_cos_f32 v90, v89
    v_sin_f32 v91, v89
    v_pk_mul_f32 v[78:79], v[78:79], v[76:77] op_sel_hi:[1,0] neg_hi:[1,0]
    v_pk_mul_f32 v[82:83], v[82:83], v[80:81] op_sel_hi:[1,0] neg_hi:[1,0]
    v_pk_mul_f32 v[86:87], v[86:87], v[84:85] op_sel_hi:[1,0] neg_hi:[1,0]
    v_pk_mul_f32 v[90:91], v[90:91], v[88:89] op_sel_hi:[1,0]
    v_pk_mul_f32 v[88:89], v[90:91], v[64:65] op_sel_hi:[1,0]
    v_pk_fma_f32 v[88:89], v[90:91], v[64:65], v[88:89] op_sel:[1,1,0] op_sel_hi:[0,1,1] neg_lo:[1,0,0]
    v_cvt_pk_bf16_f32 v32, v78, v79
    v_lshlrev_b32 v66, 16, v32
    v_and_b32 v67, 0xffff0000, v32
    v_pk_add_f32 v[66:67], v[78:79], v[66:67] neg_lo:[0,1] neg_hi:[0,1]
    v_cvt_pk_bf16_f32 v44, v66, v67
    v_cvt_pk_bf16_f32 v36, v82, v83
    v_lshlrev_b32 v66, 16, v36
    v_and_b32 v67, 0xffff0000, v36
    v_pk_add_f32 v[66:67], v[82:83], v[66:67] neg_lo:[0,1] neg_hi:[0,1]
    v_cvt_pk_bf16_f32 v48, v66, v67
    v_cvt_pk_bf16_f32 v40, v86, v87
    v_lshlrev_b32 v66, 16, v40
    v_and_b32 v67, 0xffff0000, v40
    v_pk_add_f32 v[66:67], v[86:87], v[66:67] neg_lo:[0,1] neg_hi:[0,1]
    v_cvt_pk_bf16_f32 v52, v66, v67
    v_cvt_pk_bf16_f32 v68, v88, v89
    v_lshlrev_b32 v66, 16, v68
    v_and_b32 v67, 0xffff0000, v68
    v_pk_add_f32 v[66:67], v[88:89], v[66:67] neg_lo:[0,1] neg_hi:[0,1]
    v_cvt_pk_bf16_f32 v72, v66, v67
    v_and_b32 v76, 0xffff0000, v8
    v_and_b32 v77, 0xffff0000, v12
    v_and_b32 v78, 0xffff0000, v16
    v_and_b32 v79, 0xffff0000, v20
    v_and_b32 v80, 0xffff0000, v24
    v_and_b32 v81, 0xffff0000, v28
    v_pk_mul_f32 v[62:63], v[76:77], v[60:61]
    v_pk_mul_f32 v[78:79], v[78:79], v[60:61]
    v_pk_mul_f32 v[62:63], v[62:63], s[6:7]
    v_pk_mul_f32 v[64:65], v[78:79], v[80:81] op_sel_hi:[1,0]
    v_pk_fma_f32 v[64:65], v[78:79], v[80:81], v[64:65] op_sel:[1,1,0] op_sel_hi:[0,1,1] neg_lo:[1,0,0]
    v_pk_mul_f32 v[76:77], v[62:63], v[56:57] op_sel_hi:[1,0]
    v_pk_mul_f32 v[80:81], v[62:63], v[56:57] op_sel:[0,1] op_sel_hi:[1,1]
    v_pk_mul_f32 v[84:85], v[62:63], v[58:59] op_sel_hi:[1,0]
    v_pk_mul_f32 v[88:89], v[62:63], v[58:59] op_sel:[0,1] op_sel_hi:[1,1]
    v_fract_f32 v77, v77
    v_fract_f32 v81, v81
    v_fract_f32 v85, v85
    v_fract_f32 v89, v89
    v_exp_f32 v76, v76
    v_cos_f32 v78, v77
    v_sin_f32 v79, v77
    v_exp_f32 v80, v80
    v_cos_f32 v82, v81
    v_sin_f32 v83, v81
    v_exp_f32 v84, v84
    v_cos_f32 v86, v85
    v_sin_f32 v87, v85
    v_exp_f32 v88, v88
    v_cos_f32 v90, v89
    v_sin_f32 v91, v89
    v_pk_mul_f32 v[78:79], v[78:79], v[76:77] op_sel_hi:[1,0] neg_hi:[1,0]
    v_pk_mul_f32 v[82:83], v[82:83], v[80:81] op_sel_hi:[1,0] neg_hi:[1,0]
    v_pk_mul_f32 v[86:87], v[86:87], v[84:85] op_sel_hi:[1,0] neg_hi:[1,0]
    v_pk_mul_f32 v[90:91], v[90:91], v[88:89] op_sel_hi:[1,0]
    v_pk_mul_f32 v[88:89], v[90:91], v[64:65] op_sel_hi:[1,0]
    v_pk_fma_f32 v[88:89], v[90:91], v[64:65], v[88:89] op_sel:[1,1,0] op_sel_hi:[0,1,1] neg_lo:[1,0,0]
    v_cvt_pk_bf16_f32 v33, v78, v79
    v_lshlrev_b32 v66, 16, v33
    v_and_b32 v67, 0xffff0000, v33
    v_pk_add_f32 v[66:67], v[78:79], v[66:67] neg_lo:[0,1] neg_hi:[0,1]
    v_cvt_pk_bf16_f32 v45, v66, v67
    v_cvt_pk_bf16_f32 v37, v82, v83
    v_lshlrev_b32 v66, 16, v37
    v_and_b32 v67, 0xffff0000, v37
    v_pk_add_f32 v[66:67], v[82:83], v[66:67] neg_lo:[0,1] neg_hi:[0,1]
    v_cvt_pk_bf16_f32 v49, v66, v67
    v_cvt_pk_bf16_f32 v41, v86, v87
    v_lshlrev_b32 v66, 16, v41
    v_and_b32 v67, 0xffff0000, v41
    v_pk_add_f32 v[66:67], v[86:87], v[66:67] neg_lo:[0,1] neg_hi:[0,1]
    v_cvt_pk_bf16_f32 v53, v66, v67
    v_cvt_pk_bf16_f32 v69, v88, v89
    v_lshlrev_b32 v66, 16, v69
    v_and_b32 v67, 0xffff0000, v69
    v_pk_add_f32 v[66:67], v[88:89], v[66:67] neg_lo:[0,1] neg_hi:[0,1]
    v_cvt_pk_bf16_f32 v73, v66, v67
    v_lshlrev_b32 v76, 16, v9
    v_lshlrev_b32 v77, 16, v13
    v_lshlrev_b32 v78, 16, v17
    v_lshlrev_b32 v79, 16, v21
    v_lshlrev_b32 v80, 16, v25
    v_lshlrev_b32 v81, 16, v29
    v_pk_mul_f32 v[62:63], v[76:77], v[60:61]
    v_pk_mul_f32 v[78:79], v[78:79], v[60:61]
    v_pk_mul_f32 v[62:63], v[62:63], s[6:7]
    v_pk_mul_f32 v[64:65], v[78:79], v[80:81] op_sel_hi:[1,0]
    v_pk_fma_f32 v[64:65], v[78:79], v[80:81], v[64:65] op_sel:[1,1,0] op_sel_hi:[0,1,1] neg_lo:[1,0,0]
    v_pk_mul_f32 v[76:77], v[62:63], v[56:57] op_sel_hi:[1,0]
    v_pk_mul_f32 v[80:81], v[62:63], v[56:57] op_sel:[0,1] op_sel_hi:[1,1]
    v_pk_mul_f32 v[84:85], v[62:63], v[58:59] op_sel_hi:[1,0]
    v_pk_mul_f32 v[88:89], v[62:63], v[58:59] op_sel:[0,1] op_sel_hi:[1,1]
    v_fract_f32 v77, v77
    v_fract_f32 v81, v81
    v_fract_f32 v85, v85
    v_fract_f32 v89, v89
    v_exp_f32 v76, v76
    v_cos_f32 v78, v77
    v_sin_f32 v79, v77
    v_exp_f32 v80, v80
    v_cos_f32 v82, v81
    v_sin_f32 v83, v81
    v_exp_f32 v84, v84
    v_cos_f32 v86, v85
    v_sin_f32 v87, v85
    v_exp_f32 v88, v88
    v_cos_f32 v90, v89
    v_sin_f32 v91, v89
    v_pk_mul_f32 v[78:79], v[78:79], v[76:77] op_sel_hi:[1,0] neg_hi:[1,0]
    v_pk_mul_f32 v[82:83], v[82:83], v[80:81] op_sel_hi:[1,0] neg_hi:[1,0]
    v_pk_mul_f32 v[86:87], v[86:87], v[84:85] op_sel_hi:[1,0] neg_hi:[1,0]
    v_pk_mul_f32 v[90:91], v[90:91], v[88:89] op_sel_hi:[1,0]
    v_pk_mul_f32 v[88:89], v[90:91], v[64:65] op_sel_hi:[1,0]
    v_pk_fma_f32 v[88:89], v[90:91], v[64:65], v[88:89] op_sel:[1,1,0] op_sel_hi:[0,1,1] neg_lo:[1,0,0]
    v_cvt_pk_bf16_f32 v34, v78, v79
    v_lshlrev_b32 v66, 16, v34
    v_and_b32 v67, 0xffff0000, v34
    v_pk_add_f32 v[66:67], v[78:79], v[66:67] neg_lo:[0,1] neg_hi:[0,1]
    v_cvt_pk_bf16_f32 v46, v66, v67
    v_cvt_pk_bf16_f32 v38, v82, v83
    v_lshlrev_b32 v66, 16, v38
    v_and_b32 v67, 0xffff0000, v38
    v_pk_add_f32 v[66:67], v[82:83], v[66:67] neg_lo:[0,1] neg_hi:[0,1]
    v_cvt_pk_bf16_f32 v50, v66, v67
    v_cvt_pk_bf16_f32 v42, v86, v87
    v_lshlrev_b32 v66, 16, v42
    v_and_b32 v67, 0xffff0000, v42
    v_pk_add_f32 v[66:67], v[86:87], v[66:67] neg_lo:[0,1] neg_hi:[0,1]
    v_cvt_pk_bf16_f32 v54, v66, v67
    v_cvt_pk_bf16_f32 v70, v88, v89
    v_lshlrev_b32 v66, 16, v70
    v_and_b32 v67, 0xffff0000, v70
    v_pk_add_f32 v[66:67], v[88:89], v[66:67] neg_lo:[0,1] neg_hi:[0,1]
    v_cvt_pk_bf16_f32 v74, v66, v67
    v_and_b32 v76, 0xffff0000, v9
    v_and_b32 v77, 0xffff0000, v13
    v_and_b32 v78, 0xffff0000, v17
    v_and_b32 v79, 0xffff0000, v21
    v_and_b32 v80, 0xffff0000, v25
    v_and_b32 v81, 0xffff0000, v29
    v_pk_mul_f32 v[62:63], v[76:77], v[60:61]
    v_pk_mul_f32 v[78:79], v[78:79], v[60:61]
    v_pk_mul_f32 v[62:63], v[62:63], s[6:7]
    v_pk_mul_f32 v[64:65], v[78:79], v[80:81] op_sel_hi:[1,0]
    v_pk_fma_f32 v[64:65], v[78:79], v[80:81], v[64:65] op_sel:[1,1,0] op_sel_hi:[0,1,1] neg_lo:[1,0,0]
    v_pk_mul_f32 v[76:77], v[62:63], v[56:57] op_sel_hi:[1,0]
    v_pk_mul_f32 v[80:81], v[62:63], v[56:57] op_sel:[0,1] op_sel_hi:[1,1]
    v_pk_mul_f32 v[84:85], v[62:63], v[58:59] op_sel_hi:[1,0]
    v_pk_mul_f32 v[88:89], v[62:63], v[58:59] op_sel:[0,1] op_sel_hi:[1,1]
    v_fract_f32 v77, v77
    v_fract_f32 v81, v81
    v_fract_f32 v85, v85
    v_fract_f32 v89, v89
    v_exp_f32 v76, v76
    v_cos_f32 v78, v77
    v_sin_f32 v79, v77
    v_exp_f32 v80, v80
    v_cos_f32 v82, v81
    v_sin_f32 v83, v81
    v_exp_f32 v84, v84
    v_cos_f32 v86, v85
    v_sin_f32 v87, v85
    v_exp_f32 v88, v88
    v_cos_f32 v90, v89
    v_sin_f32 v91, v89
    v_pk_mul_f32 v[78:79], v[78:79], v[76:77] op_sel_hi:[1,0] neg_hi:[1,0]
    v_pk_mul_f32 v[82:83], v[82:83], v[80:81] op_sel_hi:[1,0] neg_hi:[1,0]
    v_pk_mul_f32 v[86:87], v[86:87], v[84:85] op_sel_hi:[1,0] neg_hi:[1,0]
    v_pk_mul_f32 v[90:91], v[90:91], v[88:89] op_sel_hi:[1,0]
    v_pk_mul_f32 v[88:89], v[90:91], v[64:65] op_sel_hi:[1,0]
    v_pk_fma_f32 v[88:89], v[90:91], v[64:65], v[88:89] op_sel:[1,1,0] op_sel_hi:[0,1,1] neg_lo:[1,0,0]
    v_cvt_pk_bf16_f32 v35, v78, v79
    v_lshlrev_b32 v66, 16, v35
    v_and_b32 v67, 0xffff0000, v35
    v_pk_add_f32 v[66:67], v[78:79], v[66:67] neg_lo:[0,1] neg_hi:[0,1]
    v_cvt_pk_bf16_f32 v47, v66, v67
    v_cvt_pk_bf16_f32 v39, v82, v83
    v_lshlrev_b32 v66, 16, v39
    v_and_b32 v67, 0xffff0000, v39
    v_pk_add_f32 v[66:67], v[82:83], v[66:67] neg_lo:[0,1] neg_hi:[0,1]
    v_cvt_pk_bf16_f32 v51, v66, v67
    v_cvt_pk_bf16_f32 v43, v86, v87
    v_lshlrev_b32 v66, 16, v43
    v_and_b32 v67, 0xffff0000, v43
    v_pk_add_f32 v[66:67], v[86:87], v[66:67] neg_lo:[0,1] neg_hi:[0,1]
    v_cvt_pk_bf16_f32 v55, v66, v67
    v_cvt_pk_bf16_f32 v71, v88, v89
    v_lshlrev_b32 v66, 16, v71
    v_and_b32 v67, 0xffff0000, v71
    v_pk_add_f32 v[66:67], v[88:89], v[66:67] neg_lo:[0,1] neg_hi:[0,1]
    v_cvt_pk_bf16_f32 v75, v66, v67
    v_mfma_f32_16x16x32_bf16 v[92:95], v[44:47], v[68:71], 0
    v_mfma_f32_16x16x32_bf16 v[96:99], v[48:51], v[68:71], 0
    v_mfma_f32_16x16x32_bf16 v[100:103], v[52:55], v[68:71], 0
    v_mfma_f32_16x16x32_bf16 v[92:95], v[32:35], v[72:75], v[92:95]
    v_mfma_f32_16x16x32_bf16 v[96:99], v[36:39], v[72:75], v[96:99]
    v_mfma_f32_16x16x32_bf16 v[100:103], v[40:43], v[72:75], v[100:103]
    v_mfma_f32_16x16x32_bf16 v[92:95], v[32:35], v[68:71], v[92:95]
    v_mfma_f32_16x16x32_bf16 v[96:99], v[36:39], v[68:71], v[96:99]
    v_mfma_f32_16x16x32_bf16 v[100:103], v[40:43], v[68:71], v[100:103]
    v_lshlrev_b32 v76, 16, v10
    v_lshlrev_b32 v77, 16, v14
    v_lshlrev_b32 v78, 16, v18
    v_lshlrev_b32 v79, 16, v22
    v_lshlrev_b32 v80, 16, v26
    v_lshlrev_b32 v81, 16, v30
    v_pk_mul_f32 v[62:63], v[76:77], v[60:61]
    v_pk_mul_f32 v[78:79], v[78:79], v[60:61]
    v_pk_mul_f32 v[62:63], v[62:63], s[6:7]
    v_pk_mul_f32 v[64:65], v[78:79], v[80:81] op_sel_hi:[1,0]
    v_pk_fma_f32 v[64:65], v[78:79], v[80:81], v[64:65] op_sel:[1,1,0] op_sel_hi:[0,1,1] neg_lo:[1,0,0]
    v_pk_mul_f32 v[76:77], v[62:63], v[56:57] op_sel_hi:[1,0]
    v_pk_mul_f32 v[80:81], v[62:63], v[56:57] op_sel:[0,1] op_sel_hi:[1,1]
    v_pk_mul_f32 v[84:85], v[62:63], v[58:59] op_sel_hi:[1,0]
    v_pk_mul_f32 v[88:89], v[62:63], v[58:59] op_sel:[0,1] op_sel_hi:[1,1]
    v_fract_f32 v77, v77
    v_fract_f32 v81, v81
    v_fract_f32 v85, v85
    v_fract_f32 v89, v89
    v_exp_f32 v76, v76
    v_cos_f32 v78, v77
    v_sin_f32 v79, v77
    v_exp_f32 v80, v80
    v_cos_f32 v82, v81
    v_sin_f32 v83, v81
    v_exp_f32 v84, v84
    v_cos_f32 v86, v85
    v_sin_f32 v87, v85
    v_exp_f32 v88, v88
    v_cos_f32 v90, v89
    v_sin_f32 v91, v89
    v_pk_mul_f32 v[78:79], v[78:79], v[76:77] op_sel_hi:[1,0] neg_hi:[1,0]
    v_pk_mul_f32 v[82:83], v[82:83], v[80:81] op_sel_hi:[1,0] neg_hi:[1,0]
    v_pk_mul_f32 v[86:87], v[86:87], v[84:85] op_sel_hi:[1,0] neg_hi:[1,0]
    v_pk_mul_f32 v[90:91], v[90:91], v[88:89] op_sel_hi:[1,0]
    v_pk_mul_f32 v[88:89], v[90:91], v[64:65] op_sel_hi:[1,0]
    v_pk_fma_f32 v[88:89], v[90:91], v[64:65], v[88:89] op_sel:[1,1,0] op_sel_hi:[0,1,1] neg_lo:[1,0,0]
    v_cvt_pk_bf16_f32 v32, v78, v79
    v_lshlrev_b32 v66, 16, v32
    v_and_b32 v67, 0xffff0000, v32
    v_pk_add_f32 v[66:67], v[78:79], v[66:67] neg_lo:[0,1] neg_hi:[0,1]
    v_cvt_pk_bf16_f32 v44, v66, v67
    v_cvt_pk_bf16_f32 v36, v82, v83
    v_lshlrev_b32 v66, 16, v36
    v_and_b32 v67, 0xffff0000, v36
    v_pk_add_f32 v[66:67], v[82:83], v[66:67] neg_lo:[0,1] neg_hi:[0,1]
    v_cvt_pk_bf16_f32 v48, v66, v67
    v_cvt_pk_bf16_f32 v40, v86, v87
    v_lshlrev_b32 v66, 16, v40
    v_and_b32 v67, 0xffff0000, v40
    v_pk_add_f32 v[66:67], v[86:87], v[66:67] neg_lo:[0,1] neg_hi:[0,1]
    v_cvt_pk_bf16_f32 v52, v66, v67
    v_cvt_pk_bf16_f32 v68, v88, v89
    v_lshlrev_b32 v66, 16, v68
    v_and_b32 v67, 0xffff0000, v68
    v_pk_add_f32 v[66:67], v[88:89], v[66:67] neg_lo:[0,1] neg_hi:[0,1]
    v_cvt_pk_bf16_f32 v72, v66, v67
    v_and_b32 v76, 0xffff0000, v10
    v_and_b32 v77, 0xffff0000, v14
    v_and_b32 v78, 0xffff0000, v18
    v_and_b32 v79, 0xffff0000, v22
    v_and_b32 v80, 0xffff0000, v26
    v_and_b32 v81, 0xffff0000, v30
    v_pk_mul_f32 v[62:63], v[76:77], v[60:61]
    v_pk_mul_f32 v[78:79], v[78:79], v[60:61]
    v_pk_mul_f32 v[62:63], v[62:63], s[6:7]
    v_pk_mul_f32 v[64:65], v[78:79], v[80:81] op_sel_hi:[1,0]
    v_pk_fma_f32 v[64:65], v[78:79], v[80:81], v[64:65] op_sel:[1,1,0] op_sel_hi:[0,1,1] neg_lo:[1,0,0]
    v_pk_mul_f32 v[76:77], v[62:63], v[56:57] op_sel_hi:[1,0]
    v_pk_mul_f32 v[80:81], v[62:63], v[56:57] op_sel:[0,1] op_sel_hi:[1,1]
    v_pk_mul_f32 v[84:85], v[62:63], v[58:59] op_sel_hi:[1,0]
    v_pk_mul_f32 v[88:89], v[62:63], v[58:59] op_sel:[0,1] op_sel_hi:[1,1]
    v_fract_f32 v77, v77
    v_fract_f32 v81, v81
    v_fract_f32 v85, v85
    v_fract_f32 v89, v89
    v_exp_f32 v76, v76
    v_cos_f32 v78, v77
    v_sin_f32 v79, v77
    v_exp_f32 v80, v80
    v_cos_f32 v82, v81
    v_sin_f32 v83, v81
    v_exp_f32 v84, v84
    v_cos_f32 v86, v85
    v_sin_f32 v87, v85
    v_exp_f32 v88, v88
    v_cos_f32 v90, v89
    v_sin_f32 v91, v89
    v_pk_mul_f32 v[78:79], v[78:79], v[76:77] op_sel_hi:[1,0] neg_hi:[1,0]
    v_pk_mul_f32 v[82:83], v[82:83], v[80:81] op_sel_hi:[1,0] neg_hi:[1,0]
    v_pk_mul_f32 v[86:87], v[86:87], v[84:85] op_sel_hi:[1,0] neg_hi:[1,0]
    v_pk_mul_f32 v[90:91], v[90:91], v[88:89] op_sel_hi:[1,0]
    v_pk_mul_f32 v[88:89], v[90:91], v[64:65] op_sel_hi:[1,0]
    v_pk_fma_f32 v[88:89], v[90:91], v[64:65], v[88:89] op_sel:[1,1,0] op_sel_hi:[0,1,1] neg_lo:[1,0,0]
    v_cvt_pk_bf16_f32 v33, v78, v79
    v_lshlrev_b32 v66, 16, v33
    v_and_b32 v67, 0xffff0000, v33
    v_pk_add_f32 v[66:67], v[78:79], v[66:67] neg_lo:[0,1] neg_hi:[0,1]
    v_cvt_pk_bf16_f32 v45, v66, v67
    v_cvt_pk_bf16_f32 v37, v82, v83
    v_lshlrev_b32 v66, 16, v37
    v_and_b32 v67, 0xffff0000, v37
    v_pk_add_f32 v[66:67], v[82:83], v[66:67] neg_lo:[0,1] neg_hi:[0,1]
    v_cvt_pk_bf16_f32 v49, v66, v67
    v_cvt_pk_bf16_f32 v41, v86, v87
    v_lshlrev_b32 v66, 16, v41
    v_and_b32 v67, 0xffff0000, v41
    v_pk_add_f32 v[66:67], v[86:87], v[66:67] neg_lo:[0,1] neg_hi:[0,1]
    v_cvt_pk_bf16_f32 v53, v66, v67
    v_cvt_pk_bf16_f32 v69, v88, v89
    v_lshlrev_b32 v66, 16, v69
    v_and_b32 v67, 0xffff0000, v69
    v_pk_add_f32 v[66:67], v[88:89], v[66:67] neg_lo:[0,1] neg_hi:[0,1]
    v_cvt_pk_bf16_f32 v73, v66, v67
    v_lshlrev_b32 v76, 16, v11
    v_lshlrev_b32 v77, 16, v15
    v_lshlrev_b32 v78, 16, v19
    v_lshlrev_b32 v79, 16, v23
    v_lshlrev_b32 v80, 16, v27
    v_lshlrev_b32 v81, 16, v31
    v_pk_mul_f32 v[62:63], v[76:77], v[60:61]
    v_pk_mul_f32 v[78:79], v[78:79], v[60:61]
    v_pk_mul_f32 v[62:63], v[62:63], s[6:7]
    v_pk_mul_f32 v[64:65], v[78:79], v[80:81] op_sel_hi:[1,0]
    v_pk_fma_f32 v[64:65], v[78:79], v[80:81], v[64:65] op_sel:[1,1,0] op_sel_hi:[0,1,1] neg_lo:[1,0,0]
    v_pk_mul_f32 v[76:77], v[62:63], v[56:57] op_sel_hi:[1,0]
    v_pk_mul_f32 v[80:81], v[62:63], v[56:57] op_sel:[0,1] op_sel_hi:[1,1]
    v_pk_mul_f32 v[84:85], v[62:63], v[58:59] op_sel_hi:[1,0]
    v_pk_mul_f32 v[88:89], v[62:63], v[58:59] op_sel:[0,1] op_sel_hi:[1,1]
    v_fract_f32 v77, v77
    v_fract_f32 v81, v81
    v_fract_f32 v85, v85
    v_fract_f32 v89, v89
    v_exp_f32 v76, v76
    v_cos_f32 v78, v77
    v_sin_f32 v79, v77
    v_exp_f32 v80, v80
    v_cos_f32 v82, v81
    v_sin_f32 v83, v81
    v_exp_f32 v84, v84
    v_cos_f32 v86, v85
    v_sin_f32 v87, v85
    v_exp_f32 v88, v88
    v_cos_f32 v90, v89
    v_sin_f32 v91, v89
    v_pk_mul_f32 v[78:79], v[78:79], v[76:77] op_sel_hi:[1,0] neg_hi:[1,0]
    v_pk_mul_f32 v[82:83], v[82:83], v[80:81] op_sel_hi:[1,0] neg_hi:[1,0]
    v_pk_mul_f32 v[86:87], v[86:87], v[84:85] op_sel_hi:[1,0] neg_hi:[1,0]
    v_pk_mul_f32 v[90:91], v[90:91], v[88:89] op_sel_hi:[1,0]
    v_pk_mul_f32 v[88:89], v[90:91], v[64:65] op_sel_hi:[1,0]
    v_pk_fma_f32 v[88:89], v[90:91], v[64:65], v[88:89] op_sel:[1,1,0] op_sel_hi:[0,1,1] neg_lo:[1,0,0]
    v_cvt_pk_bf16_f32 v34, v78, v79
    v_lshlrev_b32 v66, 16, v34
    v_and_b32 v67, 0xffff0000, v34
    v_pk_add_f32 v[66:67], v[78:79], v[66:67] neg_lo:[0,1] neg_hi:[0,1]
    v_cvt_pk_bf16_f32 v46, v66, v67
    v_cvt_pk_bf16_f32 v38, v82, v83
    v_lshlrev_b32 v66, 16, v38
    v_and_b32 v67, 0xffff0000, v38
    v_pk_add_f32 v[66:67], v[82:83], v[66:67] neg_lo:[0,1] neg_hi:[0,1]
    v_cvt_pk_bf16_f32 v50, v66, v67
    v_cvt_pk_bf16_f32 v42, v86, v87
    v_lshlrev_b32 v66, 16, v42
    v_and_b32 v67, 0xffff0000, v42
    v_pk_add_f32 v[66:67], v[86:87], v[66:67] neg_lo:[0,1] neg_hi:[0,1]
    v_cvt_pk_bf16_f32 v54, v66, v67
    v_cvt_pk_bf16_f32 v70, v88, v89
    v_lshlrev_b32 v66, 16, v70
    v_and_b32 v67, 0xffff0000, v70
    v_pk_add_f32 v[66:67], v[88:89], v[66:67] neg_lo:[0,1] neg_hi:[0,1]
    v_cvt_pk_bf16_f32 v74, v66, v67
    v_and_b32 v76, 0xffff0000, v11
    v_and_b32 v77, 0xffff0000, v15
    v_and_b32 v78, 0xffff0000, v19
    v_and_b32 v79, 0xffff0000, v23
    v_and_b32 v80, 0xffff0000, v27
    v_and_b32 v81, 0xffff0000, v31
    v_pk_mul_f32 v[62:63], v[76:77], v[60:61]
    v_pk_mul_f32 v[78:79], v[78:79], v[60:61]
    v_pk_mul_f32 v[62:63], v[62:63], s[6:7]
    v_pk_mul_f32 v[64:65], v[78:79], v[80:81] op_sel_hi:[1,0]
    v_pk_fma_f32 v[64:65], v[78:79], v[80:81], v[64:65] op_sel:[1,1,0] op_sel_hi:[0,1,1] neg_lo:[1,0,0]
    v_pk_mul_f32 v[76:77], v[62:63], v[56:57] op_sel_hi:[1,0]
    v_pk_mul_f32 v[80:81], v[62:63], v[56:57] op_sel:[0,1] op_sel_hi:[1,1]
    v_pk_mul_f32 v[84:85], v[62:63], v[58:59] op_sel_hi:[1,0]
    v_pk_mul_f32 v[88:89], v[62:63], v[58:59] op_sel:[0,1] op_sel_hi:[1,1]
    v_fract_f32 v77, v77
    v_fract_f32 v81, v81
    v_fract_f32 v85, v85
    v_fract_f32 v89, v89
    v_exp_f32 v76, v76
    v_cos_f32 v78, v77
    v_sin_f32 v79, v77
    v_exp_f32 v80, v80
    v_cos_f32 v82, v81
    v_sin_f32 v83, v81
    v_exp_f32 v84, v84
    v_cos_f32 v86, v85
    v_sin_f32 v87, v85
    v_exp_f32 v88, v88
    v_cos_f32 v90, v89
    v_sin_f32 v91, v89
    v_pk_mul_f32 v[78:79], v[78:79], v[76:77] op_sel_hi:[1,0] neg_hi:[1,0]
    v_pk_mul_f32 v[82:83], v[82:83], v[80:81] op_sel_hi:[1,0] neg_hi:[1,0]
    v_pk_mul_f32 v[86:87], v[86:87], v[84:85] op_sel_hi:[1,0] neg_hi:[1,0]
    v_pk_mul_f32 v[90:91], v[90:91], v[88:89] op_sel_hi:[1,0]
    v_pk_mul_f32 v[88:89], v[90:91], v[64:65] op_sel_hi:[1,0]
    v_pk_fma_f32 v[88:89], v[90:91], v[64:65], v[88:89] op_sel:[1,1,0] op_sel_hi:[0,1,1] neg_lo:[1,0,0]
    v_cvt_pk_bf16_f32 v35, v78, v79
    v_lshlrev_b32 v66, 16, v35
    v_and_b32 v67, 0xffff0000, v35
    v_pk_add_f32 v[66:67], v[78:79], v[66:67] neg_lo:[0,1] neg_hi:[0,1]
    v_cvt_pk_bf16_f32 v47, v66, v67
    v_cvt_pk_bf16_f32 v39, v82, v83
    v_lshlrev_b32 v66, 16, v39
    v_and_b32 v67, 0xffff0000, v39
    v_pk_add_f32 v[66:67], v[82:83], v[66:67] neg_lo:[0,1] neg_hi:[0,1]
    v_cvt_pk_bf16_f32 v51, v66, v67
    v_cvt_pk_bf16_f32 v43, v86, v87
    v_lshlrev_b32 v66, 16, v43
    v_and_b32 v67, 0xffff0000, v43
    v_pk_add_f32 v[66:67], v[86:87], v[66:67] neg_lo:[0,1] neg_hi:[0,1]
    v_cvt_pk_bf16_f32 v55, v66, v67
    v_cvt_pk_bf16_f32 v71, v88, v89
    v_lshlrev_b32 v66, 16, v71
    v_and_b32 v67, 0xffff0000, v71
    v_pk_add_f32 v[66:67], v[88:89], v[66:67] neg_lo:[0,1] neg_hi:[0,1]
    v_cvt_pk_bf16_f32 v75, v66, v67
    v_mfma_f32_16x16x32_bf16 v[92:95], v[44:47], v[68:71], v[92:95]
    v_mfma_f32_16x16x32_bf16 v[96:99], v[48:51], v[68:71], v[96:99]
    v_mfma_f32_16x16x32_bf16 v[100:103], v[52:55], v[68:71], v[100:103]
    v_mfma_f32_16x16x32_bf16 v[92:95], v[32:35], v[72:75], v[92:95]
    v_mfma_f32_16x16x32_bf16 v[96:99], v[36:39], v[72:75], v[96:99]
    v_mfma_f32_16x16x32_bf16 v[100:103], v[40:43], v[72:75], v[100:103]
    v_mfma_f32_16x16x32_bf16 v[92:95], v[32:35], v[68:71], v[92:95]
    v_mfma_f32_16x16x32_bf16 v[96:99], v[36:39], v[68:71], v[96:99]
    v_mfma_f32_16x16x32_bf16 v[100:103], v[40:43], v[68:71], v[100:103]
    s_mov_b32 s4, s40
    s_mov_b32 s5, s41
    s_mov_b32 s24, s64
    s_mov_b32 s29, s65
    s_lshl_b32 s33, s2, 8
    s_add_u32 s8, s4, 0x500000
    s_addc_u32 s9, s5, 0
    s_mov_b32 s10, 0x200000
    s_mov_b32 s11, 0x00020000
    s_add_u32 s12, s4, 0xd00000
    s_addc_u32 s13, s5, 0
    s_mov_b32 s14, 0x4000
    s_mov_b32 s15, 0x00020000
    s_add_u32 s20, s4, 0x700000
    s_addc_u32 s21, s5, 0
    s_mov_b32 s22, 0x200000
    s_mov_b32 s23, 0x00020000
    s_mov_b32 s16, s62
    s_mov_b32 s17, s63
    s_mov_b32 s18, 0x100
    s_mov_b32 s19, 0x00020000
    v_bfe_u32 v4, v0, 4, 2
    s_mul_i32 s6, s24, 3072
    v_lshlrev_b32 v3, 8, v4
    v_lshl_add_u32 v3, v2, 2, v3
    v_add_u32 v3, s6, v3
    ds_write_b32 v3, v92 offset:5632
    ds_write_b32 v3, v93 offset:5696
    ds_write_b32 v3, v94 offset:5760
    ds_write_b32 v3, v95 offset:5824
    ds_write_b32 v3, v96 offset:6656
    ds_write_b32 v3, v97 offset:6720
    ds_write_b32 v3, v98 offset:6784
    ds_write_b32 v3, v99 offset:6848
    ds_write_b32 v3, v100 offset:7680
    ds_write_b32 v3, v101 offset:7744
    ds_write_b32 v3, v102 offset:7808
    ds_write_b32 v3, v103 offset:7872
    v_lshrrev_b32 v136, 4, v0
    v_lshlrev_b32 v136, 17, v136
    v_and_b32 v1, 15, v0
    v_lshl_add_u32 v136, v1, 4, v136
    v_lshlrev_b32 v2, 6, v0
    v_mov_b32 v6, 0
    buffer_load_dword v131, v6, s[16:19], 0 offen sc1
    s_waitcnt lgkmcnt(0)
    s_barrier
    v_lshlrev_b32 v3, 2, v0
    ds_read_b32 v32, v3 offset:5632
    ds_read_b32 v33, v3 offset:8704
    ds_read_b32 v34, v3 offset:11776
    ds_read_b32 v35, v3 offset:14848
    ds_read_b32 v36, v3 offset:6656
    ds_read_b32 v37, v3 offset:9728
    ds_read_b32 v38, v3 offset:12800
    ds_read_b32 v39, v3 offset:15872
    ds_read_b32 v40, v3 offset:7680
    ds_read_b32 v41, v3 offset:10752
    ds_read_b32 v42, v3 offset:13824
    ds_read_b32 v43, v3 offset:16896
    v_mov_b32 v8, 0
    v_mov_b32 v9, 20992
    ds_write_b32 v9, v8
    s_waitcnt lgkmcnt(0)
    v_add_f32 v32, v32, v33
    v_add_f32 v34, v34, v35
    v_add_f32 v32, v32, v34
    ds_write_b32 v3, v32 offset:17920
    v_add_f32 v36, v36, v37
    v_add_f32 v38, v38, v39
    v_add_f32 v36, v36, v38
    ds_write_b32 v3, v36 offset:18944
    v_add_f32 v40, v40, v41
    v_add_f32 v42, v42, v43
    v_add_f32 v40, v40, v42
    ds_write_b32 v3, v40 offset:19968
    v_cmp_gt_u32 vcc, 129, v0
    s_nop 1
    v_cndmask_b32 v40, 0, v40, vcc
    v_max3_f32 v33, abs(v32), abs(v36), abs(v40)
    s_nop 1
    v_max_f32_dpp v33, v33, v33 row_shr:1 row_mask:0xf bank_mask:0xf bound_ctrl:0
    s_nop 1
    v_max_f32_dpp v33, v33, v33 row_shr:2 row_mask:0xf bank_mask:0xf bound_ctrl:0
    s_nop 1
    v_max_f32_dpp v33, v33, v33 row_shr:4 row_mask:0xf bank_mask:0xf bound_ctrl:0
    s_nop 1
    v_max_f32_dpp v33, v33, v33 row_shr:8 row_mask:0xf bank_mask:0xf bound_ctrl:0
    s_nop 1
    v_max_f32_dpp v33, v33, v33 row_bcast:15 row_mask:0xa bank_mask:0xf
    s_nop 1
    v_max_f32_dpp v33, v33, v33 row_bcast:31 row_mask:0xc bank_mask:0xf
    s_lshl_b32 s6, s24, 2
    v_mov_b32 v8, s6
    v_and_b32 v9, 63, v0
    v_cmp_eq_u32 vcc, 63, v9
    s_nop 0
    s_and_saveexec_b64 s[30:31], vcc
    ds_write_b32 v8, v33 offset:21008
    s_mov_b64 exec, s[30:31]
    s_waitcnt lgkmcnt(0)
    s_barrier
    v_mov_b32 v8, 0
    ds_read_b128 v[34:37], v8 offset:21008
    s_waitcnt lgkmcnt(0)
    v_max3_f32 v32, v34, v35, v36
    v_max_f32 v32, v32, v37
    v_frexp_exp_i32_f32 v32, v32
    v_sub_u32 v48, 15, v32
    v_sub_u32 v33, 0, v48
    v_ldexp_f32 v33, 1.0, v33
    s_nop 0
    v_readfirstlane_b32 s32, v33
    s_mul_i32 s6, s2, 5120
    v_and_b32 v72, 0xffff, v104
    ds_read_b32 v64, v72 offset:17920
    v_lshrrev_b32 v73, 16, v104
    ds_read_b32 v65, v73 offset:17920
    v_and_b32 v74, 0xffff, v105
    ds_read_b32 v66, v74 offset:17920
    v_lshrrev_b32 v75, 16, v105
    ds_read_b32 v67, v75 offset:17920
    v_and_b32 v76, 0xffff, v106
    ds_read_b32 v68, v76 offset:17920
    v_lshrrev_b32 v77, 16, v106
    ds_read_b32 v69, v77 offset:17920
    v_and_b32 v78, 0xffff, v107
    ds_read_b32 v70, v78 offset:17920
    v_lshrrev_b32 v79, 16, v107
    ds_read_b32 v71, v79 offset:17920
    v_lshlrev_b32 v3, 4, v0
    s_waitcnt lgkmcnt(0)
    v_ldexp_f32 v64, v64, v48
    v_ldexp_f32 v65, v65, v48
    v_ldexp_f32 v66, v66, v48
    v_ldexp_f32 v67, v67, v48
    v_ldexp_f32 v68, v68, v48
    v_ldexp_f32 v69, v69, v48
    v_ldexp_f32 v70, v70, v48
    v_ldexp_f32 v71, v71, v48
    v_cvt_pk_f16_f32 v80, v64, v65
    v_cvt_pk_f16_f32 v81, v66, v67
    v_cvt_pk_f16_f32 v82, v68, v69
    v_cvt_pk_f16_f32 v83, v70, v71
    ds_write_b128 v3, v[80:83] offset:512
    buffer_store_dwordx4 v[80:83], v3, s[44:47], s6 offen sc1
    s_cmp_lg_u32 s24, 0
    s_cbranch_scc1 front_noex2
    v_cmp_gt_u32 vcc, 32, v0
    s_nop 0
    s_and_saveexec_b64 s[30:31], vcc
    s_nop 1
    v_and_b32 v72, 0xffff, v108
    ds_read_b32 v64, v72 offset:17920
    v_lshrrev_b32 v73, 16, v108
    ds_read_b32 v65, v73 offset:17920
    v_and_b32 v74, 0xffff, v109
    ds_read_b32 v66, v74 offset:17920
    v_lshrrev_b32 v75, 16, v109
    ds_read_b32 v67, v75 offset:17920
    v_and_b32 v76, 0xffff, v110
    ds_read_b32 v68, v76 offset:17920
    v_lshrrev_b32 v77, 16, v110
    ds_read_b32 v69, v77 offset:17920
    v_and_b32 v78, 0xffff, v111
    ds_read_b32 v70, v78 offset:17920
    v_lshrrev_b32 v79, 16, v111
    ds_read_b32 v71, v79 offset:17920
    v_lshlrev_b32 v3, 4, v0
    v_add_u32 v3, 4096, v3
    s_waitcnt lgkmcnt(0)
    v_ldexp_f32 v64, v64, v48
    v_ldexp_f32 v65, v65, v48
    v_ldexp_f32 v66, v66, v48
    v_ldexp_f32 v67, v67, v48
    v_ldexp_f32 v68, v68, v48
    v_ldexp_f32 v69, v69, v48
    v_ldexp_f32 v70, v70, v48
    v_ldexp_f32 v71, v71, v48
    v_cvt_pk_f16_f32 v80, v64, v65
    v_cvt_pk_f16_f32 v81, v66, v67
    v_cvt_pk_f16_f32 v82, v68, v69
    v_cvt_pk_f16_f32 v83, v70, v71
    ds_write_b128 v3, v[80:83] offset:512
    buffer_store_dwordx4 v[80:83], v3, s[44:47], s6 offen sc1
    v_mov_b32 v8, 4608
    v_cmp_eq_u32 vcc, 0, v0
    s_nop 0
    s_and_b64 exec, exec, vcc
    buffer_store_dword v33, v8, s[44:47], s6 offen sc1
    s_mov_b64 exec, s[30:31]
    s_add_u32 s48, s4, 0xd38000
    s_addc_u32 s49, s5, 0
    s_mov_b32 s50, 0x2000
    s_mov_b32 s51, 0x00020000
    s_and_b32 s30, s2, 15
    s_lshl_b32 s28, s30, 9
    v_lshlrev_b32 v8, 3, v0
    v_mov_b32 v6, 0
    s_mov_b32 s31, 0
    s_waitcnt vmcnt(3)
front_poll:
    v_readfirstlane_b32 s34, v131
    s_nop 0
    s_cmp_lg_u32 s34, 0
    s_cbranch_scc1 front_havenonce
    buffer_load_dword v131, v6, s[16:19], 0 offen sc1
    s_waitcnt vmcnt(0)
    s_branch front_again
front_havenonce:
    buffer_load_dwordx2 v[10:11], v8, s[48:51], s28 offen sc1
    s_waitcnt vmcnt(0)
    v_xor_b32 v10, s34, v10
    v_xor_b32 v11, s34, v11
    v_or_b32 v10, v10, v11
    v_cmp_ne_u32 vcc, 0, v10
    s_nop 0
    s_cmp_eq_u64 vcc, 0
    s_cbranch_scc1 front_noex2
front_again:
    s_add_u32 s31, s31, 1
    s_cmp_ge_u32 s31, 0x40000
    s_cbranch_scc1 front_noex2
    s_sleep 4
    s_branch front_poll
front_noex2:
    s_nop 1
    s_waitcnt lgkmcnt(0)
    s_barrier
    buffer_load_dwordx4 v[4:7], v136, s[8:11], s33 offen sc1
    buffer_load_dwordx4 v[16:19], v2, s[12:15], 0 offen offset:0 sc1
    buffer_load_dwordx4 v[20:23], v2, s[12:15], 0 offen offset:16 sc1
    buffer_load_dwordx4 v[24:27], v2, s[12:15], 0 offen offset:32 sc1
    buffer_load_dwordx4 v[28:31], v2, s[12:15], 0 offen offset:48 sc1
    v_mov_b32 v56, 0
    v_mov_b32 v57, 0
    v_mov_b32 v58, 0
    v_mov_b32 v59, 0
    v_lshrrev_b32 v1, 5, v0
    v_and_b32 v2, 31, v0
    v_mul_u32_u24 v1, 4640, v1
    v_cmp_eq_u32 vcc, 20, v2
    v_mov_b32 v3, 276
    s_nop 0
    v_cndmask_b32 v3, v2, v3, vcc
    v_lshl_add_u32 v1, v3, 4, v1
    v_cmp_gt_u32 vcc, 21, v2
    s_nop 0
    s_and_saveexec_b64 s[30:31], vcc
    ds_write_b128 v1, v[56:59] offset:5632
    s_mov_b64 exec, s[30:31]
    v_and_b32 v2, 15, v0
    v_bfe_u32 v3, v0, 4, 2
    v_sub_u32 v144, v3, v2
    v_lshlrev_b32 v144, 4, v144
    s_lshl_b32 s25, s24, 6
    s_sub_u32 s26, 752, s25
    v_add_u32 v144, s26, v144
    v_and_b32 v60, 7, v2
    v_mul_u32_u24 v145, 4640, v60
    v_lshrrev_b32 v61, 3, v2
    v_lshl_add_u32 v145, v61, 8, v145
    v_lshl_add_u32 v145, v3, 4, v145
    s_sub_u32 s26, 5632, s25
    v_add_u32 v145, s26, v145
    v_subrev_u32 v146, 256, v144
    v_subrev_u32 v147, 256, v145
    v_lshlrev_b32 v62, 2, v60
    v_lshl_add_u32 v62, v61, 9, v62
    v_lshl_add_u32 v62, v3, 7, v62
    s_lshl_b32 s25, s24, 13
    v_add_u32 v62, s25, v62
    v_and_b32 v63, 1, v3
    v_lshl_or_b32 v63, v61, 1, v63
    v_xor_b32 v150, 0, v63
    v_lshl_add_u32 v150, v150, 5, v62
    v_xor_b32 v151, 1, v63
    v_lshl_add_u32 v151, v151, 5, v62
    v_xor_b32 v152, 2, v63
    v_lshl_add_u32 v152, v152, 5, v62
    v_xor_b32 v153, 3, v63
    v_lshl_add_u32 v153, v153, 5, v62
    v_bfe_u32 v154, v0, 2, 1
    v_bfe_u32 v3, v0, 4, 1
    v_lshl_or_b32 v154, v3, 1, v154
    v_xor_b32 v154, v154, v0
    v_lshlrev_b32 v154, 5, v154
    v_and_b32 v2, 7, v0
    v_lshrrev_b32 v3, 3, v0
    v_lshlrev_b32 v148, 1, v2
    v_mul_u32_u24 v149, 4638, v3
    v_add_u32 v149, v149, v148
    v_cmp_lt_u32 vcc, v2, v3
    v_cmp_gt_u32 s[42:43], 64, v0
    s_nop 0
    s_and_b64 s[42:43], vcc, s[42:43]
    v_lshlrev_b32 v1, 4, v0
    s_mov_b32 s40, 0x3b000000
    s_mov_b32 s41, 0x3b000000
    s_waitcnt vmcnt(0)
    v_lshlrev_b32 v48, 16, v4
    v_and_b32 v49, 0xffff0000, v4
    v_lshlrev_b32 v50, 16, v5
    v_and_b32 v51, 0xffff0000, v5
    v_lshlrev_b32 v52, 16, v6
    v_and_b32 v53, 0xffff0000, v6
    v_lshlrev_b32 v54, 16, v7
    v_and_b32 v55, 0xffff0000, v7
    v_pk_add_f32 v[48:49], v[48:49], v[16:17] neg_lo:[0,1] neg_hi:[0,1]
    v_pk_add_f32 v[50:51], v[50:51], v[18:19] neg_lo:[0,1] neg_hi:[0,1]
    v_pk_add_f32 v[52:53], v[52:53], v[20:21] neg_lo:[0,1] neg_hi:[0,1]
    v_pk_add_f32 v[54:55], v[54:55], v[22:23] neg_lo:[0,1] neg_hi:[0,1]
    v_cvt_pk_bf16_f32 v60, v48, v49
    v_lshlrev_b32 v48, 16, v60
    v_and_b32 v49, 0xffff0000, v60
    v_cvt_pk_bf16_f32 v60, v50, v51
    v_lshlrev_b32 v50, 16, v60
    v_and_b32 v51, 0xffff0000, v60
    v_cvt_pk_bf16_f32 v60, v52, v53
    v_lshlrev_b32 v52, 16, v60
    v_and_b32 v53, 0xffff0000, v60
    v_cvt_pk_bf16_f32 v60, v54, v55
    v_lshlrev_b32 v54, 16, v60
    v_and_b32 v55, 0xffff0000, v60
    v_pk_mul_f32 v[48:49], v[48:49], v[24:25]
    v_pk_mul_f32 v[50:51], v[50:51], v[26:27]
    v_pk_mul_f32 v[52:53], v[52:53], v[28:29]
    v_pk_mul_f32 v[54:55], v[54:55], v[30:31]
    v_cvt_pk_bf16_f32 v140, v48, v49
    v_cvt_pk_bf16_f32 v141, v50, v51
    v_cvt_pk_bf16_f32 v142, v52, v53
    v_cvt_pk_bf16_f32 v143, v54, v55
    v_lshlrev_b32 v48, 16, v140
    v_and_b32 v49, 0xffff0000, v140
    v_lshlrev_b32 v50, 16, v141
    v_and_b32 v51, 0xffff0000, v141
    v_lshlrev_b32 v52, 16, v142
    v_and_b32 v53, 0xffff0000, v142
    v_lshlrev_b32 v54, 16, v143
    v_and_b32 v55, 0xffff0000, v143
    v_cvt_pk_f16_f32 v8, v48, v49
    v_cvt_pk_f16_f32 v9, v50, v51
    v_cvt_pk_f16_f32 v10, v52, v53
    v_cvt_pk_f16_f32 v11, v54, v55
    ds_write_b128 v1, v[8:11] offset:5952
    s_waitcnt lgkmcnt(0)
    s_barrier
    ds_read_b128 v[12:15], v1 offset:5968
    ds_read_u16 v58, v148 offset:5952
    s_waitcnt lgkmcnt(0)
    s_and_saveexec_b64 s[30:31], s[42:43]
    ds_write_b16 v149, v58 offset:5952
    s_mov_b64 exec, s[30:31]
    v_alignbit_b32 v16, v9, v8, 16
    v_alignbit_b32 v17, v10, v9, 16
    v_alignbit_b32 v18, v11, v10, 16
    v_alignbit_b32 v19, v12, v11, 16
    ds_write_b128 v1, v[16:19] offset:10592
    v_mov_b32 v20, v9
    v_mov_b32 v21, v10
    v_mov_b32 v22, v11
    v_mov_b32 v23, v12
    ds_write_b128 v1, v[20:23] offset:15232
    v_alignbit_b32 v24, v10, v9, 16
    v_alignbit_b32 v25, v11, v10, 16
    v_alignbit_b32 v26, v12, v11, 16
    v_alignbit_b32 v27, v13, v12, 16
    ds_write_b128 v1, v[24:27] offset:19872
    ds_write_b128 v1, v[10:13] offset:24512
    v_alignbit_b32 v32, v11, v10, 16
    v_alignbit_b32 v33, v12, v11, 16
    v_alignbit_b32 v34, v13, v12, 16
    v_alignbit_b32 v35, v14, v13, 16
    ds_write_b128 v1, v[32:35] offset:29152
    v_mov_b32 v36, v11
    v_mov_b32 v37, v12
    v_mov_b32 v38, v13
    v_mov_b32 v39, v14
    ds_write_b128 v1, v[36:39] offset:33792
    v_alignbit_b32 v40, v12, v11, 16
    v_alignbit_b32 v41, v13, v12, 16
    v_alignbit_b32 v42, v14, v13, 16
    v_alignbit_b32 v43, v15, v14, 16
    ds_write_b128 v1, v[40:43] offset:38432
    s_waitcnt vmcnt(0) lgkmcnt(0)
    s_barrier
    ds_read_b128 v[100:103], v145 offset:512
    ds_read_b128 v[64:67], v144 offset:4096
    ds_read_b128 v[68:71], v144 offset:3584
    ds_read_b128 v[72:75], v144 offset:3072
    ds_read_b128 v[76:79], v144 offset:2560
    ds_read_b128 v[80:83], v144 offset:2048
    ds_read_b128 v[84:87], v144 offset:1536
    ds_read_b128 v[88:91], v144 offset:1024
    s_waitcnt lgkmcnt(7)
    s_waitcnt lgkmcnt(6)
    v_mfma_f32_16x16x32_f16 v[32:35], v[64:67], v[100:103], 0
    ds_read_b128 v[92:95], v144 offset:512
    s_waitcnt lgkmcnt(6)
    v_mfma_f32_16x16x32_f16 v[36:39], v[68:71], v[100:103], 0
    ds_read_b128 v[104:107], v145 offset:1024
    s_waitcnt lgkmcnt(6)
    v_mfma_f32_16x16x32_f16 v[40:43], v[72:75], v[100:103], 0
    ds_read_b128 v[108:111], v145 offset:1536
    s_waitcnt lgkmcnt(6)
    v_mfma_f32_16x16x32_f16 v[44:47], v[76:79], v[100:103], 0
    ds_read_b128 v[112:115], v145 offset:2048
    s_waitcnt lgkmcnt(6)
    v_mfma_f32_16x16x32_f16 v[48:51], v[80:83], v[100:103], 0
    ds_read_b128 v[116:119], v145 offset:2560
    s_waitcnt lgkmcnt(6)
    v_mfma_f32_16x16x32_f16 v[52:55], v[84:87], v[100:103], 0
    ds_read_b128 v[120:123], v145 offset:3072
    s_waitcnt lgkmcnt(6)
    v_mfma_f32_16x16x32_f16 v[56:59], v[88:91], v[100:103], 0
    ds_read_b128 v[124:127], v145 offset:3584
    s_waitcnt lgkmcnt(6)
    v_mfma_f32_16x16x32_f16 v[60:63], v[92:95], v[100:103], 0
    ds_read_b128 v[128:131], v145 offset:4096
    s_waitcnt lgkmcnt(0)
    s_cmp_lg_u32 s24, 0
    s_cbranch_scc1 front_noext
    ds_read_b128 v[96:99], v144 offset:0
    ds_read_b128 v[132:135], v145 offset:0
    s_waitcnt lgkmcnt(0)
    v_mfma_f32_16x16x32_f16 v[32:35], v[68:71], v[132:135], v[32:35]
    v_mfma_f32_16x16x32_f16 v[36:39], v[72:75], v[132:135], v[36:39]
    v_mfma_f32_16x16x32_f16 v[40:43], v[76:79], v[132:135], v[40:43]
    v_mfma_f32_16x16x32_f16 v[44:47], v[80:83], v[132:135], v[44:47]
    v_mfma_f32_16x16x32_f16 v[48:51], v[84:87], v[132:135], v[48:51]
    v_mfma_f32_16x16x32_f16 v[52:55], v[88:91], v[132:135], v[52:55]
    v_mfma_f32_16x16x32_f16 v[56:59], v[92:95], v[132:135], v[56:59]
    v_mfma_f32_16x16x32_f16 v[60:63], v[96:99], v[132:135], v[60:63]
front_noext:
    ds_read_b128 v[100:103], v147 offset:512
    ds_read_b128 v[92:95], v146 offset:4096
    v_mfma_f32_16x16x32_f16 v[36:39], v[64:67], v[104:107], v[36:39]
    v_mfma_f32_16x16x32_f16 v[40:43], v[68:71], v[104:107], v[40:43]
    v_mfma_f32_16x16x32_f16 v[44:47], v[72:75], v[104:107], v[44:47]
    v_mfma_f32_16x16x32_f16 v[48:51], v[76:79], v[104:107], v[48:51]
    v_mfma_f32_16x16x32_f16 v[52:55], v[80:83], v[104:107], v[52:55]
    v_mfma_f32_16x16x32_f16 v[56:59], v[84:87], v[104:107], v[56:59]
    v_mfma_f32_16x16x32_f16 v[60:63], v[88:91], v[104:107], v[60:63]
    ds_read_b128 v[104:107], v147 offset:1024
    ds_read_b128 v[88:91], v146 offset:3584
    v_mfma_f32_16x16x32_f16 v[40:43], v[64:67], v[108:111], v[40:43]
    v_mfma_f32_16x16x32_f16 v[44:47], v[68:71], v[108:111], v[44:47]
    v_mfma_f32_16x16x32_f16 v[48:51], v[72:75], v[108:111], v[48:51]
    v_mfma_f32_16x16x32_f16 v[52:55], v[76:79], v[108:111], v[52:55]
    v_mfma_f32_16x16x32_f16 v[56:59], v[80:83], v[108:111], v[56:59]
    v_mfma_f32_16x16x32_f16 v[60:63], v[84:87], v[108:111], v[60:63]
    ds_read_b128 v[108:111], v147 offset:1536
    ds_read_b128 v[84:87], v146 offset:3072
    v_mfma_f32_16x16x32_f16 v[44:47], v[64:67], v[112:115], v[44:47]
    v_mfma_f32_16x16x32_f16 v[48:51], v[68:71], v[112:115], v[48:51]
    v_mfma_f32_16x16x32_f16 v[52:55], v[72:75], v[112:115], v[52:55]
    v_mfma_f32_16x16x32_f16 v[56:59], v[76:79], v[112:115], v[56:59]
    v_mfma_f32_16x16x32_f16 v[60:63], v[80:83], v[112:115], v[60:63]
    ds_read_b128 v[112:115], v147 offset:2048
    ds_read_b128 v[80:83], v146 offset:2560
    v_mfma_f32_16x16x32_f16 v[48:51], v[64:67], v[116:119], v[48:51]
    v_mfma_f32_16x16x32_f16 v[52:55], v[68:71], v[116:119], v[52:55]
    v_mfma_f32_16x16x32_f16 v[56:59], v[72:75], v[116:119], v[56:59]
    v_mfma_f32_16x16x32_f16 v[60:63], v[76:79], v[116:119], v[60:63]
    ds_read_b128 v[116:119], v147 offset:2560
    ds_read_b128 v[76:79], v146 offset:2048
    v_mfma_f32_16x16x32_f16 v[52:55], v[64:67], v[120:123], v[52:55]
    v_mfma_f32_16x16x32_f16 v[56:59], v[68:71], v[120:123], v[56:59]
    v_mfma_f32_16x16x32_f16 v[60:63], v[72:75], v[120:123], v[60:63]
    ds_read_b128 v[120:123], v147 offset:3072
    ds_read_b128 v[72:75], v146 offset:1536
    v_mfma_f32_16x16x32_f16 v[56:59], v[64:67], v[124:127], v[56:59]
    v_mfma_f32_16x16x32_f16 v[60:63], v[68:71], v[124:127], v[60:63]
    ds_read_b128 v[124:127], v147 offset:3584
    ds_read_b128 v[68:71], v146 offset:1024
    v_mfma_f32_16x16x32_f16 v[60:63], v[64:67], v[128:131], v[60:63]
    ds_read_b128 v[128:131], v147 offset:4096
    s_waitcnt lgkmcnt(14)
    ds_read_b128 v[64:67], v146 offset:512
    s_waitcnt lgkmcnt(14)
    v_mfma_f32_16x16x32_f16 v[32:35], v[92:95], v[100:103], v[32:35]
    s_waitcnt lgkmcnt(12)
    v_mfma_f32_16x16x32_f16 v[36:39], v[88:91], v[100:103], v[36:39]
    s_waitcnt lgkmcnt(10)
    v_mfma_f32_16x16x32_f16 v[40:43], v[84:87], v[100:103], v[40:43]
    s_waitcnt lgkmcnt(8)
    v_mfma_f32_16x16x32_f16 v[44:47], v[80:83], v[100:103], v[44:47]
    s_waitcnt lgkmcnt(6)
    v_mfma_f32_16x16x32_f16 v[48:51], v[76:79], v[100:103], v[48:51]
    s_waitcnt lgkmcnt(4)
    v_mfma_f32_16x16x32_f16 v[52:55], v[72:75], v[100:103], v[52:55]
    s_waitcnt lgkmcnt(2)
    v_mfma_f32_16x16x32_f16 v[56:59], v[68:71], v[100:103], v[56:59]
    s_waitcnt lgkmcnt(0)
    v_mfma_f32_16x16x32_f16 v[60:63], v[64:67], v[100:103], v[60:63]
    v_mfma_f32_16x16x32_f16 v[36:39], v[92:95], v[104:107], v[36:39]
    v_mfma_f32_16x16x32_f16 v[40:43], v[88:91], v[104:107], v[40:43]
    v_mfma_f32_16x16x32_f16 v[44:47], v[84:87], v[104:107], v[44:47]
    v_mfma_f32_16x16x32_f16 v[48:51], v[80:83], v[104:107], v[48:51]
    v_mfma_f32_16x16x32_f16 v[52:55], v[76:79], v[104:107], v[52:55]
    v_mfma_f32_16x16x32_f16 v[56:59], v[72:75], v[104:107], v[56:59]
    v_mfma_f32_16x16x32_f16 v[60:63], v[68:71], v[104:107], v[60:63]
    v_mfma_f32_16x16x32_f16 v[40:43], v[92:95], v[108:111], v[40:43]
    v_mfma_f32_16x16x32_f16 v[44:47], v[88:91], v[108:111], v[44:47]
    v_mfma_f32_16x16x32_f16 v[48:51], v[84:87], v[108:111], v[48:51]
    v_mfma_f32_16x16x32_f16 v[52:55], v[80:83], v[108:111], v[52:55]
    v_mfma_f32_16x16x32_f16 v[56:59], v[76:79], v[108:111], v[56:59]
    v_mfma_f32_16x16x32_f16 v[60:63], v[72:75], v[108:111], v[60:63]
    v_mfma_f32_16x16x32_f16 v[44:47], v[92:95], v[112:115], v[44:47]
    v_mfma_f32_16x16x32_f16 v[48:51], v[88:91], v[112:115], v[48:51]
    v_mfma_f32_16x16x32_f16 v[52:55], v[84:87], v[112:115], v[52:55]
    v_mfma_f32_16x16x32_f16 v[56:59], v[80:83], v[112:115], v[56:59]
    v_mfma_f32_16x16x32_f16 v[60:63], v[76:79], v[112:115], v[60:63]
    v_mfma_f32_16x16x32_f16 v[48:51], v[92:95], v[116:119], v[48:51]
    v_mfma_f32_16x16x32_f16 v[52:55], v[88:91], v[116:119], v[52:55]
    v_mfma_f32_16x16x32_f16 v[56:59], v[84:87], v[116:119], v[56:59]
    v_mfma_f32_16x16x32_f16 v[60:63], v[80:83], v[116:119], v[60:63]
    v_mfma_f32_16x16x32_f16 v[52:55], v[92:95], v[120:123], v[52:55]
    v_mfma_f32_16x16x32_f16 v[56:59], v[88:91], v[120:123], v[56:59]
    v_mfma_f32_16x16x32_f16 v[60:63], v[84:87], v[120:123], v[60:63]
    v_mfma_f32_16x16x32_f16 v[56:59], v[92:95], v[124:127], v[56:59]
    v_mfma_f32_16x16x32_f16 v[60:63], v[88:91], v[124:127], v[60:63]
    v_mfma_f32_16x16x32_f16 v[60:63], v[92:95], v[128:131], v[60:63]
    s_barrier
    ds_write_b32 v150, v32 offset:5632
    ds_write_b32 v151, v33 offset:5632
    ds_write_b32 v152, v34 offset:5632
    ds_write_b32 v153, v35 offset:5632
    ds_write_b32 v150, v36 offset:6656
    ds_write_b32 v151, v37 offset:6656
    ds_write_b32 v152, v38 offset:6656
    ds_write_b32 v153, v39 offset:6656
    ds_write_b32 v150, v40 offset:7680
    ds_write_b32 v151, v41 offset:7680
    ds_write_b32 v152, v42 offset:7680
    ds_write_b32 v153, v43 offset:7680
    s_waitcnt lgkmcnt(0)
    ds_write_b32 v150, v44 offset:8704
    ds_write_b32 v151, v45 offset:8704
    ds_write_b32 v152, v46 offset:8704
    ds_write_b32 v153, v47 offset:8704
    ds_write_b32 v150, v48 offset:9728
    ds_write_b32 v151, v49 offset:9728
    ds_write_b32 v152, v50 offset:9728
    ds_write_b32 v153, v51 offset:9728
    ds_write_b32 v150, v52 offset:10752
    ds_write_b32 v151, v53 offset:10752
    ds_write_b32 v152, v54 offset:10752
    ds_write_b32 v153, v55 offset:10752
    s_waitcnt lgkmcnt(0)
    ds_write_b32 v150, v56 offset:11776
    ds_write_b32 v151, v57 offset:11776
    ds_write_b32 v152, v58 offset:11776
    ds_write_b32 v153, v59 offset:11776
    ds_write_b32 v150, v60 offset:12800
    ds_write_b32 v151, v61 offset:12800
    ds_write_b32 v152, v62 offset:12800
    ds_write_b32 v153, v63 offset:12800
    s_waitcnt lgkmcnt(0)
    s_barrier
    ds_read_b128 v[64:67], v154 offset:5632
    ds_read_b128 v[68:71], v154 offset:5648
    ds_read_b128 v[72:75], v154 offset:13824
    ds_read_b128 v[76:79], v154 offset:13840
    ds_read_b128 v[80:83], v154 offset:22016
    ds_read_b128 v[84:87], v154 offset:22032
    ds_read_b128 v[88:91], v154 offset:30208
    ds_read_b128 v[92:95], v154 offset:30224
    s_and_b32 s25, s2, 1
    s_lshl_b32 s25, s25, 4
    s_lshr_b32 s29, s29, s25
    s_lshl_b32 s29, s29, 16
    s_mov_b32 s30, s29
    s_mov_b32 s31, s29
    s_mov_b32 s40, s32
    s_mov_b32 s41, s32
    v_lshlrev_b32 v16, 16, v140
    v_and_b32 v17, 0xffff0000, v140
    v_lshlrev_b32 v18, 16, v141
    v_and_b32 v19, 0xffff0000, v141
    v_lshlrev_b32 v20, 16, v142
    v_and_b32 v21, 0xffff0000, v142
    v_lshlrev_b32 v22, 16, v143
    v_and_b32 v23, 0xffff0000, v143
    v_pk_mul_f32 v[16:17], v[16:17], s[30:31]
    v_pk_mul_f32 v[18:19], v[18:19], s[30:31]
    v_pk_mul_f32 v[20:21], v[20:21], s[30:31]
    v_pk_mul_f32 v[22:23], v[22:23], s[30:31]
    v_cvt_pk_bf16_f32 v56, v16, v17
    v_lshlrev_b32 v16, 16, v56
    v_and_b32 v17, 0xffff0000, v56
    v_cvt_pk_bf16_f32 v56, v18, v19
    v_lshlrev_b32 v18, 16, v56
    v_and_b32 v19, 0xffff0000, v56
    v_cvt_pk_bf16_f32 v56, v20, v21
    v_lshlrev_b32 v20, 16, v56
    v_and_b32 v21, 0xffff0000, v56
    v_cvt_pk_bf16_f32 v56, v22, v23
    v_lshlrev_b32 v22, 16, v56
    v_and_b32 v23, 0xffff0000, v56
    v_lshlrev_b32 v48, 16, v4
    v_and_b32 v49, 0xffff0000, v4
    v_lshlrev_b32 v50, 16, v5
    v_and_b32 v51, 0xffff0000, v5
    v_lshlrev_b32 v52, 16, v6
    v_and_b32 v53, 0xffff0000, v6
    v_lshlrev_b32 v54, 16, v7
    v_and_b32 v55, 0xffff0000, v7
    s_waitcnt lgkmcnt(0)
    v_pk_add_f32 v[64:65], v[64:65], v[72:73]
    v_pk_add_f32 v[80:81], v[80:81], v[88:89]
    v_pk_add_f32 v[66:67], v[66:67], v[74:75]
    v_pk_add_f32 v[82:83], v[82:83], v[90:91]
    v_pk_add_f32 v[68:69], v[68:69], v[76:77]
    v_pk_add_f32 v[84:85], v[84:85], v[92:93]
    v_pk_add_f32 v[70:71], v[70:71], v[78:79]
    v_pk_add_f32 v[86:87], v[86:87], v[94:95]
    v_pk_add_f32 v[64:65], v[64:65], v[80:81]
    v_pk_add_f32 v[66:67], v[66:67], v[82:83]
    v_pk_add_f32 v[68:69], v[68:69], v[84:85]
    v_pk_add_f32 v[70:71], v[70:71], v[86:87]
    v_pk_mul_f32 v[64:65], v[64:65], s[40:41]
    v_pk_mul_f32 v[66:67], v[66:67], s[40:41]
    v_pk_mul_f32 v[68:69], v[68:69], s[40:41]
    v_pk_mul_f32 v[70:71], v[70:71], s[40:41]
    v_cvt_pk_bf16_f32 v56, v64, v65
    v_lshlrev_b32 v64, 16, v56
    v_and_b32 v65, 0xffff0000, v56
    v_cvt_pk_bf16_f32 v56, v66, v67
    v_lshlrev_b32 v66, 16, v56
    v_and_b32 v67, 0xffff0000, v56
    v_cvt_pk_bf16_f32 v56, v68, v69
    v_lshlrev_b32 v68, 16, v56
    v_and_b32 v69, 0xffff0000, v56
    v_cvt_pk_bf16_f32 v56, v70, v71
    v_lshlrev_b32 v70, 16, v56
    v_and_b32 v71, 0xffff0000, v56
    v_pk_add_f32 v[64:65], v[64:65], v[16:17]
    v_pk_add_f32 v[66:67], v[66:67], v[18:19]
    v_pk_add_f32 v[68:69], v[68:69], v[20:21]
    v_pk_add_f32 v[70:71], v[70:71], v[22:23]
    v_cvt_pk_bf16_f32 v56, v64, v65
    v_lshlrev_b32 v64, 16, v56
    v_and_b32 v65, 0xffff0000, v56
    v_cvt_pk_bf16_f32 v56, v66, v67
    v_lshlrev_b32 v66, 16, v56
    v_and_b32 v67, 0xffff0000, v56
    v_cvt_pk_bf16_f32 v56, v68, v69
    v_lshlrev_b32 v68, 16, v56
    v_and_b32 v69, 0xffff0000, v56
    v_cvt_pk_bf16_f32 v56, v70, v71
    v_lshlrev_b32 v70, 16, v56
    v_and_b32 v71, 0xffff0000, v56
    v_pk_add_f32 v[64:65], v[64:65], v[48:49]
    v_pk_add_f32 v[66:67], v[66:67], v[50:51]
    v_pk_add_f32 v[68:69], v[68:69], v[52:53]
    v_pk_add_f32 v[70:71], v[70:71], v[54:55]
    v_cvt_pk_bf16_f32 v56, v64, v65
    v_cvt_pk_bf16_f32 v57, v66, v67
    v_cvt_pk_bf16_f32 v58, v68, v69
    v_cvt_pk_bf16_f32 v59, v70, v71
    buffer_store_dwordx4 v[56:59], v136, s[20:23], s33 offen sc1
    s_add_u32 s2, s2, 256
    s_endpgm
front_roles:
    s_nop 1
    s_setprio 3
    s_cmp_ge_u32 s2, 128
    s_cbranch_scc1 front_wroles
    s_and_b32 s3, s2, 63
    s_lshl_b32 s4, s3, 15
    s_lshl_b32 s5, s3, 8
    v_lshlrev_b32 v1, 4, v0
    v_add_u32 v1, s4, v1
    s_waitcnt lgkmcnt(0)
    global_load_dwordx4 v[8:11], v1, s[16:17]
    v_add_u32 v1, 0x1000, v1
    global_load_dwordx4 v[12:15], v1, s[16:17]
    v_add_u32 v1, 0x1000, v1
    global_load_dwordx4 v[16:19], v1, s[16:17]
    v_add_u32 v1, 0x1000, v1
    global_load_dwordx4 v[20:23], v1, s[16:17]
    v_add_u32 v1, 0x1000, v1
    global_load_dwordx4 v[24:27], v1, s[16:17]
    v_add_u32 v1, 0x1000, v1
    global_load_dwordx4 v[28:31], v1, s[16:17]
    v_add_u32 v1, 0x1000, v1
    global_load_dwordx4 v[32:35], v1, s[16:17]
    v_add_u32 v1, 0x1000, v1
    global_load_dwordx4 v[36:39], v1, s[16:17]
    s_mov_b32 s12, s62
    s_mov_b32 s13, s63
    s_mov_b32 s14, 0x100
    s_mov_b32 s15, 0x00020000
    v_mov_b32 v62, 0
    s_cmp_lg_u32 s2, 0
    s_cbranch_scc1 front_nononce
    s_memrealtime s[64:65]
    s_waitcnt lgkmcnt(0)
    s_mul_i32 s65, s65, 0x9e3779b9
    s_xor_b32 s64, s64, s65
    s_or_b32 s64, s64, 1
    v_mov_b32 v60, s64
    v_cmp_eq_u32 vcc, 0, v0
    s_nop 0
    s_and_saveexec_b64 s[66:67], vcc
    buffer_store_dword v60, v62, s[12:15], 0 offen sc1
    s_mov_b64 exec, s[66:67]
    s_waitcnt vmcnt(0)
front_nononce:
    s_nop 1
    v_lshrrev_b32 v2, 6, v0
    v_and_b32 v3, 63, v0
    v_and_b32 v5, 15, v0
    v_bfe_u32 v6, v0, 4, 2
    s_cmp_ge_u32 s2, 64
    s_cbranch_scc1 front_srole
    s_lshr_b32 s6, s2, 2
    s_lshl_b32 s6, s6, 17
    s_and_b32 s7, s2, 3
    s_lshl_b32 s7, s7, 6
    s_add_u32 s6, s6, s7
    s_add_u32 s8, s40, 0x500000
    s_addc_u32 s9, s41, 0
    s_mov_b32 s10, 0x200000
    s_mov_b32 s11, 0x00020000
    v_mul_u32_u24 v4, 1056, v2
    v_lshl_add_u32 v4, v3, 4, v4
    s_waitcnt vmcnt(7)
    ds_write_b128 v4, v[8:11] offset:0
    s_waitcnt vmcnt(6)
    ds_write_b128 v4, v[12:15] offset:4224
    s_waitcnt vmcnt(5)
    ds_write_b128 v4, v[16:19] offset:8448
    s_waitcnt vmcnt(4)
    ds_write_b128 v4, v[20:23] offset:12672
    s_waitcnt vmcnt(3)
    ds_write_b128 v4, v[24:27] offset:16896
    s_waitcnt vmcnt(2)
    ds_write_b128 v4, v[28:31] offset:21120
    s_waitcnt vmcnt(1)
    ds_write_b128 v4, v[32:35] offset:25344
    s_waitcnt vmcnt(0)
    ds_write_b128 v4, v[36:39] offset:29568
    buffer_load_dword v60, v62, s[12:15], 0 offen sc1
    v_lshrrev_b32 v7, 2, v5
    v_lshl_add_u32 v7, v6, 3, v7
    v_mul_u32_u24 v7, 1056, v7
    v_and_b32 v4, 3, v0
    v_lshl_add_u32 v7, v4, 3, v7
    v_lshl_add_u32 v7, v2, 8, v7
    v_lshl_add_u32 v4, v2, 7, v5
    v_lshlrev_b32 v4, 8, v4
    v_lshl_add_u32 v4, v6, 4, v4
    v_add_u32 v4, s6, v4
    s_waitcnt lgkmcnt(0)
    s_barrier
    ds_read_b64_tr_b16 v[64:65], v7 offset:0
    ds_read_b64_tr_b16 v[66:67], v7 offset:4224
    ds_read_b64_tr_b16 v[68:69], v7 offset:32
    ds_read_b64_tr_b16 v[70:71], v7 offset:4256
    ds_read_b64_tr_b16 v[72:73], v7 offset:64
    ds_read_b64_tr_b16 v[74:75], v7 offset:4288
    ds_read_b64_tr_b16 v[76:77], v7 offset:96
    ds_read_b64_tr_b16 v[78:79], v7 offset:4320
    ds_read_b64_tr_b16 v[80:81], v7 offset:128
    ds_read_b64_tr_b16 v[82:83], v7 offset:4352
    ds_read_b64_tr_b16 v[84:85], v7 offset:160
    ds_read_b64_tr_b16 v[86:87], v7 offset:4384
    ds_read_b64_tr_b16 v[88:89], v7 offset:192
    ds_read_b64_tr_b16 v[90:91], v7 offset:4416
    ds_read_b64_tr_b16 v[92:93], v7 offset:224
    ds_read_b64_tr_b16 v[94:95], v7 offset:4448
    s_waitcnt lgkmcnt(14)
    buffer_store_dwordx4 v[64:67], v4, s[8:11], 0 offen sc1
    v_add_u32 v4, 0x1000, v4
    s_waitcnt lgkmcnt(12)
    buffer_store_dwordx4 v[68:71], v4, s[8:11], 0 offen sc1
    v_add_u32 v4, 0x1000, v4
    s_waitcnt lgkmcnt(10)
    buffer_store_dwordx4 v[72:75], v4, s[8:11], 0 offen sc1
    v_add_u32 v4, 0x1000, v4
    s_waitcnt lgkmcnt(8)
    buffer_store_dwordx4 v[76:79], v4, s[8:11], 0 offen sc1
    v_add_u32 v4, 0x1000, v4
    s_waitcnt lgkmcnt(6)
    buffer_store_dwordx4 v[80:83], v4, s[8:11], 0 offen sc1
    v_add_u32 v4, 0x1000, v4
    s_waitcnt lgkmcnt(4)
    buffer_store_dwordx4 v[84:87], v4, s[8:11], 0 offen sc1
    v_add_u32 v4, 0x1000, v4
    s_waitcnt lgkmcnt(2)
    buffer_store_dwordx4 v[88:91], v4, s[8:11], 0 offen sc1
    v_add_u32 v4, 0x1000, v4
    s_waitcnt lgkmcnt(0)
    buffer_store_dwordx4 v[92:95], v4, s[8:11], 0 offen sc1
    s_branch front_x0tail
front_srole:
    s_nop 1
    s_add_u32 s44, s40, 0xd00000
    s_addc_u32 s45, s41, 0
    s_mov_b32 s46, 0x4000
    s_mov_b32 s47, 0x00020000
    s_mov_b32 s7, 0x3f803f80
    v_mov_b32 v40, 0
    v_mov_b32 v41, 0
    v_mov_b32 v42, 0
    v_mov_b32 v43, 0
    v_mov_b32 v44, 0
    v_mov_b32 v45, 0
    v_mov_b32 v46, 0
    v_mov_b32 v47, 0
    v_mov_b32 v48, 0
    v_mov_b32 v49, 0
    v_mov_b32 v50, 0
    v_mov_b32 v51, 0
    v_mov_b32 v52, 0
    v_mov_b32 v53, 0
    v_mov_b32 v54, 0
    v_mov_b32 v55, 0
    s_waitcnt vmcnt(7)
    v_dot2_f32_bf16 v40, v8, s7, v40
    v_dot2_f32_bf16 v41, v8, v8, v41
    v_dot2_f32_bf16 v40, v9, s7, v40
    v_dot2_f32_bf16 v41, v9, v9, v41
    v_dot2_f32_bf16 v40, v10, s7, v40
    v_dot2_f32_bf16 v41, v10, v10, v41
    v_dot2_f32_bf16 v40, v11, s7, v40
    v_dot2_f32_bf16 v41, v11, v11, v41
    s_waitcnt vmcnt(6)
    v_dot2_f32_bf16 v42, v12, s7, v42
    v_dot2_f32_bf16 v43, v12, v12, v43
    v_dot2_f32_bf16 v42, v13, s7, v42
    v_dot2_f32_bf16 v43, v13, v13, v43
    v_dot2_f32_bf16 v42, v14, s7, v42
    v_dot2_f32_bf16 v43, v14, v14, v43
    v_dot2_f32_bf16 v42, v15, s7, v42
    v_dot2_f32_bf16 v43, v15, v15, v43
    s_waitcnt vmcnt(5)
    v_dot2_f32_bf16 v44, v16, s7, v44
    v_dot2_f32_bf16 v45, v16, v16, v45
    v_dot2_f32_bf16 v44, v17, s7, v44
    v_dot2_f32_bf16 v45, v17, v17, v45
    v_dot2_f32_bf16 v44, v18, s7, v44
    v_dot2_f32_bf16 v45, v18, v18, v45
    v_dot2_f32_bf16 v44, v19, s7, v44
    v_dot2_f32_bf16 v45, v19, v19, v45
    s_waitcnt vmcnt(4)
    v_dot2_f32_bf16 v46, v20, s7, v46
    v_dot2_f32_bf16 v47, v20, v20, v47
    v_dot2_f32_bf16 v46, v21, s7, v46
    v_dot2_f32_bf16 v47, v21, v21, v47
    v_dot2_f32_bf16 v46, v22, s7, v46
    v_dot2_f32_bf16 v47, v22, v22, v47
    v_dot2_f32_bf16 v46, v23, s7, v46
    v_dot2_f32_bf16 v47, v23, v23, v47
    s_waitcnt vmcnt(3)
    v_dot2_f32_bf16 v48, v24, s7, v48
    v_dot2_f32_bf16 v49, v24, v24, v49
    v_dot2_f32_bf16 v48, v25, s7, v48
    v_dot2_f32_bf16 v49, v25, v25, v49
    v_dot2_f32_bf16 v48, v26, s7, v48
    v_dot2_f32_bf16 v49, v26, v26, v49
    v_dot2_f32_bf16 v48, v27, s7, v48
    v_dot2_f32_bf16 v49, v27, v27, v49
    s_waitcnt vmcnt(2)
    v_dot2_f32_bf16 v50, v28, s7, v50
    v_dot2_f32_bf16 v51, v28, v28, v51
    v_dot2_f32_bf16 v50, v29, s7, v50
    v_dot2_f32_bf16 v51, v29, v29, v51
    v_dot2_f32_bf16 v50, v30, s7, v50
    v_dot2_f32_bf16 v51, v30, v30, v51
    v_dot2_f32_bf16 v50, v31, s7, v50
    v_dot2_f32_bf16 v51, v31, v31, v51
    s_waitcnt vmcnt(1)
    v_dot2_f32_bf16 v52, v32, s7, v52
    v_dot2_f32_bf16 v53, v32, v32, v53
    v_dot2_f32_bf16 v52, v33, s7, v52
    v_dot2_f32_bf16 v53, v33, v33, v53
    v_dot2_f32_bf16 v52, v34, s7, v52
    v_dot2_f32_bf16 v53, v34, v34, v53
    v_dot2_f32_bf16 v52, v35, s7, v52
    v_dot2_f32_bf16 v53, v35, v35, v53
    s_waitcnt vmcnt(0)
    v_dot2_f32_bf16 v54, v36, s7, v54
    v_dot2_f32_bf16 v55, v36, v36, v55
    v_dot2_f32_bf16 v54, v37, s7, v54
    v_dot2_f32_bf16 v55, v37, v37, v55
    v_dot2_f32_bf16 v54, v38, s7, v54
    v_dot2_f32_bf16 v55, v38, v38, v55
    v_dot2_f32_bf16 v54, v39, s7, v54
    v_dot2_f32_bf16 v55, v39, v39, v55
    buffer_load_dword v60, v62, s[12:15], 0 offen sc1
    s_nop 2
    v_permlane32_swap_b32 v40, v48
    v_permlane32_swap_b32 v41, v49
    v_permlane32_swap_b32 v42, v50
    v_permlane32_swap_b32 v43, v51
    v_permlane32_swap_b32 v44, v52
    v_permlane32_swap_b32 v45, v53
    v_permlane32_swap_b32 v46, v54
    v_permlane32_swap_b32 v47, v55
    v_pk_add_f32 v[40:41], v[40:41], v[48:49]
    v_pk_add_f32 v[42:43], v[42:43], v[50:51]
    v_pk_add_f32 v[44:45], v[44:45], v[52:53]
    v_pk_add_f32 v[46:47], v[46:47], v[54:55]
    s_nop 0
    v_permlane16_swap_b32 v40, v44
    v_permlane16_swap_b32 v41, v45
    v_permlane16_swap_b32 v42, v46
    v_permlane16_swap_b32 v43, v47
    v_pk_add_f32 v[40:41], v[40:41], v[44:45]
    v_pk_add_f32 v[42:43], v[42:43], v[46:47]
    s_nop 0
    v_add_f32_dpp v40, v40, v40 row_shr:1 row_mask:0xf bank_mask:0xf bound_ctrl:0
    v_add_f32_dpp v41, v41, v41 row_shr:1 row_mask:0xf bank_mask:0xf bound_ctrl:0
    v_add_f32_dpp v42, v42, v42 row_shr:1 row_mask:0xf bank_mask:0xf bound_ctrl:0
    v_add_f32_dpp v43, v43, v43 row_shr:1 row_mask:0xf bank_mask:0xf bound_ctrl:0
    v_add_f32_dpp v40, v40, v40 row_shr:2 row_mask:0xf bank_mask:0xf bound_ctrl:0
    v_add_f32_dpp v41, v41, v41 row_shr:2 row_mask:0xf bank_mask:0xf bound_ctrl:0
    v_add_f32_dpp v42, v42, v42 row_shr:2 row_mask:0xf bank_mask:0xf bound_ctrl:0
    v_add_f32_dpp v43, v43, v43 row_shr:2 row_mask:0xf bank_mask:0xf bound_ctrl:0
    v_add_f32_dpp v40, v40, v40 row_shr:4 row_mask:0xf bank_mask:0xf bound_ctrl:0
    v_add_f32_dpp v41, v41, v41 row_shr:4 row_mask:0xf bank_mask:0xf bound_ctrl:0
    v_add_f32_dpp v42, v42, v42 row_shr:4 row_mask:0xf bank_mask:0xf bound_ctrl:0
    v_add_f32_dpp v43, v43, v43 row_shr:4 row_mask:0xf bank_mask:0xf bound_ctrl:0
    v_add_f32_dpp v40, v40, v40 row_shr:8 row_mask:0xf bank_mask:0xf bound_ctrl:0
    v_add_f32_dpp v41, v41, v41 row_shr:8 row_mask:0xf bank_mask:0xf bound_ctrl:0
    v_add_f32_dpp v42, v42, v42 row_shr:8 row_mask:0xf bank_mask:0xf bound_ctrl:0
    v_add_f32_dpp v43, v43, v43 row_shr:8 row_mask:0xf bank_mask:0xf bound_ctrl:0
    s_mov_b32 s64, 0x3b000000
    s_mov_b32 s65, 0x3b000000
    v_pk_mul_f32 v[40:41], v[40:41], s[64:65]
    v_pk_mul_f32 v[42:43], v[42:43], s[64:65]
    v_fma_f32 v41, -v40, v40, v41
    v_fma_f32 v43, -v42, v42, v43
    v_max_f32 v41, 0, v41
    v_max_f32 v43, 0, v43
    v_cvt_pk_bf16_f32 v40, v40, v41
    v_cvt_pk_bf16_f32 v42, v42, v43
    v_lshlrev_b32 v48, 16, v40
    v_and_b32 v50, 0xffff0000, v40
    v_lshlrev_b32 v49, 16, v42
    v_and_b32 v51, 0xffff0000, v42
    v_mov_b32 v52, 0x3727c5ac
    v_mov_b32 v53, 0x3727c5ac
    v_pk_add_f32 v[50:51], v[50:51], v[52:53]
    v_cvt_pk_bf16_f32 v40, v50, v51
    v_lshlrev_b32 v50, 16, v40
    v_and_b32 v51, 0xffff0000, v40
    v_sqrt_f32 v50, v50
    v_sqrt_f32 v51, v51
    s_nop 0
    v_cvt_pk_bf16_f32 v40, v50, v51
    v_lshlrev_b32 v50, 16, v40
    v_and_b32 v51, 0xffff0000, v40
    v_rcp_f32 v50, v50
    v_rcp_f32 v51, v51
    v_lshlrev_b32 v7, 2, v2
    v_lshl_add_u32 v7, v6, 6, v7
    v_add_u32 v7, s5, v7
    v_cmp_eq_u32 vcc, 15, v5
    s_nop 0
    s_and_saveexec_b64 s[66:67], vcc
    buffer_store_dword v48, v7, s[44:47], 0 offen sc1
    buffer_store_dword v49, v7, s[44:47], 0 offen offset:16 sc1
    buffer_store_dword v50, v7, s[44:47], 0 offen offset:32 sc1
    buffer_store_dword v51, v7, s[44:47], 0 offen offset:48 sc1
    s_mov_b64 exec, s[66:67]
front_x0tail:
    s_nop 1
    v_mov_b32 v56, 0
    v_mov_b32 v57, 0
    v_mov_b32 v58, 0
    v_mov_b32 v59, 0
    s_add_u32 s44, s40, 0xd38000
    s_addc_u32 s45, s41, 0
    s_mov_b32 s46, 0x2000
    s_mov_b32 s47, 0x00020000
    v_lshlrev_b32 v7, 9, v0
    s_lshl_b32 s7, s2, 2
    s_waitcnt vmcnt(0)
    s_barrier
    v_readfirstlane_b32 s3, v0
    s_nop 0
    s_cmp_lg_u32 s3, 0
    s_cbranch_scc1 front_x0zero
    s_mov_b32 s31, 0
front_x0nonce:
    v_readfirstlane_b32 s3, v60
    s_nop 0
    s_cmp_lg_u32 s3, 0
    s_cbranch_scc1 front_x0pub
    buffer_load_dword v60, v62, s[12:15], 0 offen sc1
    s_waitcnt vmcnt(0)
    s_add_u32 s31, s31, 1
    s_cmp_lt_u32 s31, 0x40000
    s_cbranch_scc1 front_x0nonce
front_x0pub:
    buffer_store_dword v60, v7, s[44:47], s7 offen sc1
front_x0zero:
    s_nop 1
    s_cmp_lt_u32 s2, 64
    s_cbranch_scc1 front_x0end
    s_add_u32 s48, s40, 0xd10000
    s_addc_u32 s49, s41, 0
    s_mov_b32 s50, 0x4000
    s_mov_b32 s51, 0x00020000
    v_lshlrev_b32 v5, 4, v0
    v_cmp_gt_u32 vcc, 16, v0
    s_nop 0
    s_and_saveexec_b64 s[66:67], vcc
    buffer_store_dwordx4 v[56:59], v5, s[48:51], s5 offen sc1
    s_mov_b64 exec, s[66:67]
    s_add_u32 s48, s40, 0xd40000
    s_addc_u32 s49, s41, 0
    s_mov_b32 s50, 0x10000
    s_mov_b32 s51, 0x00020000
    s_lshl_b32 s7, s5, 2
    v_cmp_gt_u32 vcc, 64, v0
    s_nop 0
    s_and_saveexec_b64 s[66:67], vcc
    buffer_store_dwordx4 v[56:59], v5, s[48:51], s7 offen sc1
    s_add_u32 s48, s40, 0xe00000
    s_addc_u32 s49, s41, 0
    s_mov_b32 s50, 0x2c4000
    s_mov_b32 s51, 0x00020000
    s_add_u32 s7, s7, 2818048
    buffer_store_dwordx4 v[56:59], v5, s[48:51], s7 offen sc1
    s_mov_b64 exec, s[66:67]
    v_mov_b32 v52, 0x3f803f80
    v_mov_b32 v53, 0x3f803f80
    v_mov_b32 v54, 0x3f803f80
    v_mov_b32 v55, 0x3f803f80
    s_add_u32 s7, s5, 2883584
    v_cmp_gt_u32 vcc, 16, v0
    s_nop 0
    s_and_saveexec_b64 s[66:67], vcc
    buffer_store_dwordx4 v[52:55], v5, s[48:51], s7 offen sc1
    s_cmp_lg_u32 s5, 0
    s_cbranch_scc1 front_nocs
    s_add_u32 s48, s40, 0xd20000
    s_addc_u32 s49, s41, 0
    s_mov_b32 s50, 0x5800
    s_mov_b32 s51, 0x00020000
    s_mov_b32 s7, 11008
    buffer_store_dwordx4 v[56:59], v5, s[48:51], s7 offen sc1
    s_mov_b32 s7, 22272
    buffer_store_dwordx4 v[56:59], v5, s[48:51], s7 offen sc1
front_nocs:
    s_mov_b64 exec, s[66:67]
front_x0end:
    s_endpgm
front_wroles:
    s_nop 1
    s_setprio 0
    s_cmp_ge_u32 s2, 214
    s_cbranch_scc1 front_w2
    s_waitcnt lgkmcnt(0)
    s_sub_u32 s3, s2, 128
    s_lshr_b32 s4, s3, 1
    s_and_b32 s5, s3, 1
    s_cmp_ge_u32 s4, 43
    s_cselect_b32 s6, 0, 1409024
    s_mov_b32 s8, s32
    s_mov_b32 s9, s33
    s_mov_b32 s10, 0x0
    s_mov_b32 s11, 0x00020000
    s_mov_b32 s10, s6
    s_mov_b32 s12, s34
    s_mov_b32 s13, s35
    s_mov_b32 s14, 0x0
    s_mov_b32 s15, 0x00020000
    s_mov_b32 s14, s6
    s_add_u32 s44, s40, 0xe00000
    s_addc_u32 s45, s41, 0
    s_mov_b32 s46, 0x2c4000
    s_mov_b32 s47, 0x00020000
    s_add_u32 s48, s40, 0xd20000
    s_addc_u32 s49, s41, 0
    s_mov_b32 s50, 0x5800
    s_mov_b32 s51, 0x00020000
front_w1_loop:
    s_nop 3
    s_cmp_lg_u32 s4, 43
    s_cbranch_scc1 front_w1_noones
    v_mov_b32 v8, 0x3f803f80
    v_mov_b32 v9, 0x3f803f80
    v_mov_b32 v10, 0x3f803f80
    v_mov_b32 v11, 0x3f803f80
    v_lshlrev_b32 v1, 4, v0
    s_lshl_b32 s6, s5, 13
    s_add_u32 s6, s6, 2883584
    buffer_store_dwordx4 v[8:11], v1, s[44:47], s6 offen sc1
    s_add_u32 s6, s6, 4096
    buffer_store_dwordx4 v[8:11], v1, s[44:47], s6 offen sc1
    s_waitcnt vmcnt(0)
front_w1_noones:
    s_nop 1
    s_mul_i32 s6, s5, 704512
    s_lshl_b32 s7, s4, 6
    s_add_u32 s6, s6, s7
    v_lshrrev_b32 v2, 2, v0
    v_and_b32 v3, 3, v0
    v_mul_u32_u24 v1, 2752, v2
    v_lshl_add_u32 v1, v3, 4, v1
    buffer_load_dwordx4 v[8:11], v1, s[8:11], s6 offen
    buffer_load_dwordx4 v[24:27], v1, s[12:15], s6 offen
    s_add_u32 s6, s6, 176128
    buffer_load_dwordx4 v[12:15], v1, s[8:11], s6 offen
    buffer_load_dwordx4 v[28:31], v1, s[12:15], s6 offen
    s_add_u32 s6, s6, 176128
    buffer_load_dwordx4 v[16:19], v1, s[8:11], s6 offen
    buffer_load_dwordx4 v[32:35], v1, s[12:15], s6 offen
    s_add_u32 s6, s6, 176128
    buffer_load_dwordx4 v[20:23], v1, s[8:11], s6 offen
    buffer_load_dwordx4 v[36:39], v1, s[12:15], s6 offen
    v_mul_u32_u24 v4, 144, v2
    v_lshl_add_u32 v4, v3, 5, v4
    s_waitcnt vmcnt(6)
    v_mov_b32 v40, v8
    v_mov_b32 v41, v24
    v_mov_b32 v42, v9
    v_mov_b32 v43, v25
    v_mov_b32 v44, v10
    v_mov_b32 v45, v26
    v_mov_b32 v46, v11
    v_mov_b32 v47, v27
    ds_write_b128 v4, v[40:43] offset:0
    ds_write_b128 v4, v[44:47] offset:16
    s_waitcnt vmcnt(4)
    v_mov_b32 v48, v12
    v_mov_b32 v49, v28
    v_mov_b32 v50, v13
    v_mov_b32 v51, v29
    v_mov_b32 v52, v14
    v_mov_b32 v53, v30
    v_mov_b32 v54, v15
    v_mov_b32 v55, v31
    ds_write_b128 v4, v[48:51] offset:9216
    ds_write_b128 v4, v[52:55] offset:9232
    s_waitcnt vmcnt(2)
    v_mov_b32 v40, v16
    v_mov_b32 v41, v32
    v_mov_b32 v42, v17
    v_mov_b32 v43, v33
    v_mov_b32 v44, v18
    v_mov_b32 v45, v34
    v_mov_b32 v46, v19
    v_mov_b32 v47, v35
    ds_write_b128 v4, v[40:43] offset:18432
    ds_write_b128 v4, v[44:47] offset:18448
    s_waitcnt vmcnt(0)
    v_mov_b32 v48, v20
    v_mov_b32 v49, v36
    v_mov_b32 v50, v21
    v_mov_b32 v51, v37
    v_mov_b32 v52, v22
    v_mov_b32 v53, v38
    v_mov_b32 v54, v23
    v_mov_b32 v55, v39
    ds_write_b128 v4, v[48:51] offset:27648
    ds_write_b128 v4, v[52:55] offset:27664
    s_waitcnt lgkmcnt(0)
    s_barrier
    v_lshrrev_b32 v2, 6, v0
    v_and_b32 v5, 15, v0
    v_bfe_u32 v6, v0, 4, 2
    v_lshrrev_b32 v7, 2, v5
    v_lshl_add_u32 v7, v6, 3, v7
    v_mul_u32_u24 v7, 144, v7
    v_lshl_add_u32 v7, v3, 3, v7
    v_lshl_add_u32 v7, v2, 5, v7
    ds_read_b64_tr_b16 v[8:9], v7 offset:0
    ds_read_b64_tr_b16 v[10:11], v7 offset:576
    ds_read_b64_tr_b16 v[12:13], v7 offset:4608
    ds_read_b64_tr_b16 v[14:15], v7 offset:5184
    ds_read_b64_tr_b16 v[16:17], v7 offset:9216
    ds_read_b64_tr_b16 v[18:19], v7 offset:9792
    ds_read_b64_tr_b16 v[20:21], v7 offset:13824
    ds_read_b64_tr_b16 v[22:23], v7 offset:14400
    ds_read_b64_tr_b16 v[24:25], v7 offset:18432
    ds_read_b64_tr_b16 v[26:27], v7 offset:19008
    ds_read_b64_tr_b16 v[28:29], v7 offset:23040
    ds_read_b64_tr_b16 v[30:31], v7 offset:23616
    ds_read_b64_tr_b16 v[32:33], v7 offset:27648
    ds_read_b64_tr_b16 v[34:35], v7 offset:28224
    ds_read_b64_tr_b16 v[36:37], v7 offset:32256
    ds_read_b64_tr_b16 v[38:39], v7 offset:32832
    s_lshl_b32 s6, s4, 16
    s_lshl_b32 s7, s5, 13
    s_add_u32 s6, s6, s7
    v_and_b32 v3, 63, v0
    v_lshlrev_b32 v4, 14, v2
    v_lshl_add_u32 v4, v3, 4, v4
    v_add_u32 v1, 0x1000, v4
    s_mov_b32 s7, 0x3f803f80
    v_mov_b32 v40, 0
    s_waitcnt lgkmcnt(14)
    buffer_store_dwordx4 v[8:11], v4, s[44:47], s6 offen offset:0 sc1
    v_dot2_f32_bf16 v40, v8, s7, v40
    v_dot2_f32_bf16 v40, v9, s7, v40
    v_dot2_f32_bf16 v40, v10, s7, v40
    v_dot2_f32_bf16 v40, v11, s7, v40
    s_waitcnt lgkmcnt(12)
    buffer_store_dwordx4 v[12:15], v4, s[44:47], s6 offen offset:1024 sc1
    v_dot2_f32_bf16 v40, v12, s7, v40
    v_dot2_f32_bf16 v40, v13, s7, v40
    v_dot2_f32_bf16 v40, v14, s7, v40
    v_dot2_f32_bf16 v40, v15, s7, v40
    s_waitcnt lgkmcnt(10)
    buffer_store_dwordx4 v[16:19], v4, s[44:47], s6 offen offset:2048 sc1
    v_dot2_f32_bf16 v40, v16, s7, v40
    v_dot2_f32_bf16 v40, v17, s7, v40
    v_dot2_f32_bf16 v40, v18, s7, v40
    v_dot2_f32_bf16 v40, v19, s7, v40
    s_waitcnt lgkmcnt(8)
    buffer_store_dwordx4 v[20:23], v4, s[44:47], s6 offen offset:3072 sc1
    v_dot2_f32_bf16 v40, v20, s7, v40
    v_dot2_f32_bf16 v40, v21, s7, v40
    v_dot2_f32_bf16 v40, v22, s7, v40
    v_dot2_f32_bf16 v40, v23, s7, v40
    s_waitcnt lgkmcnt(6)
    buffer_store_dwordx4 v[24:27], v1, s[44:47], s6 offen offset:0 sc1
    v_dot2_f32_bf16 v40, v24, s7, v40
    v_dot2_f32_bf16 v40, v25, s7, v40
    v_dot2_f32_bf16 v40, v26, s7, v40
    v_dot2_f32_bf16 v40, v27, s7, v40
    s_waitcnt lgkmcnt(4)
    buffer_store_dwordx4 v[28:31], v1, s[44:47], s6 offen offset:1024 sc1
    v_dot2_f32_bf16 v40, v28, s7, v40
    v_dot2_f32_bf16 v40, v29, s7, v40
    v_dot2_f32_bf16 v40, v30, s7, v40
    v_dot2_f32_bf16 v40, v31, s7, v40
    s_waitcnt lgkmcnt(2)
    buffer_store_dwordx4 v[32:35], v1, s[44:47], s6 offen offset:2048 sc1
    v_dot2_f32_bf16 v40, v32, s7, v40
    v_dot2_f32_bf16 v40, v33, s7, v40
    v_dot2_f32_bf16 v40, v34, s7, v40
    v_dot2_f32_bf16 v40, v35, s7, v40
    s_waitcnt lgkmcnt(0)
    buffer_store_dwordx4 v[36:39], v1, s[44:47], s6 offen offset:3072 sc1
    v_dot2_f32_bf16 v40, v36, s7, v40
    v_dot2_f32_bf16 v40, v37, s7, v40
    v_dot2_f32_bf16 v40, v38, s7, v40
    v_dot2_f32_bf16 v40, v39, s7, v40
    v_mov_b32 v41, v40
    s_nop 1
    v_permlane16_swap_b32 v40, v41
    v_add_f32 v40, v40, v41
    v_mov_b32 v41, v40
    s_nop 1
    v_permlane32_swap_b32 v40, v41
    v_add_f32 v40, v40, v41
    s_mul_i32 s6, s5, 11264
    s_lshl_b32 s7, s4, 8
    s_add_u32 s6, s6, s7
    v_lshlrev_b32 v4, 6, v2
    v_lshl_add_u32 v4, v5, 2, v4
    v_cmp_gt_u32 vcc, 16, v3
    s_nop 0
    s_and_saveexec_b64 s[42:43], vcc
    buffer_store_dword v40, v4, s[48:51], s6 offen sc1
    s_endpgm
front_w2:
    s_nop 1
    s_waitcnt lgkmcnt(0)
    s_sub_u32 s3, s2, 214
front_w2_again:
    s_nop 3
    s_lshl_b32 s4, s3, 15
    s_lshl_b32 s6, s3, 10
    s_add_u32 s8, s40, 0x1100000
    s_addc_u32 s9, s41, 0
    s_mov_b32 s10, 0x158000
    s_mov_b32 s11, 0x00020000
    v_lshlrev_b32 v1, 4, v0
    v_add_u32 v1, s4, v1
    global_load_dwordx4 v[8:11], v1, s[36:37]
    v_add_u32 v1, 0x1000, v1
    global_load_dwordx4 v[12:15], v1, s[36:37]
    v_add_u32 v1, 0x1000, v1
    global_load_dwordx4 v[16:19], v1, s[36:37]
    v_add_u32 v1, 0x1000, v1
    global_load_dwordx4 v[20:23], v1, s[36:37]
    v_add_u32 v1, 0x1000, v1
    global_load_dwordx4 v[24:27], v1, s[36:37]
    v_add_u32 v1, 0x1000, v1
    global_load_dwordx4 v[28:31], v1, s[36:37]
    v_add_u32 v1, 0x1000, v1
    global_load_dwordx4 v[32:35], v1, s[36:37]
    v_add_u32 v1, 0x1000, v1
    global_load_dwordx4 v[36:39], v1, s[36:37]
    v_lshrrev_b32 v2, 6, v0
    v_and_b32 v3, 63, v0
    v_mul_u32_u24 v4, 1056, v2
    v_lshl_add_u32 v4, v3, 4, v4
    s_waitcnt vmcnt(7)
    ds_write_b128 v4, v[8:11] offset:0
    s_waitcnt vmcnt(6)
    ds_write_b128 v4, v[12:15] offset:4224
    s_waitcnt vmcnt(5)
    ds_write_b128 v4, v[16:19] offset:8448
    s_waitcnt vmcnt(4)
    ds_write_b128 v4, v[20:23] offset:12672
    s_waitcnt vmcnt(3)
    ds_write_b128 v4, v[24:27] offset:16896
    s_waitcnt vmcnt(2)
    ds_write_b128 v4, v[28:31] offset:21120
    s_waitcnt vmcnt(1)
    ds_write_b128 v4, v[32:35] offset:25344
    s_waitcnt vmcnt(0)
    ds_write_b128 v4, v[36:39] offset:29568
    s_waitcnt lgkmcnt(0)
    s_barrier
    v_and_b32 v5, 15, v0
    v_bfe_u32 v6, v0, 4, 2
    v_lshrrev_b32 v7, 2, v5
    v_lshl_add_u32 v7, v6, 3, v7
    v_mul_u32_u24 v7, 1056, v7
    v_and_b32 v4, 3, v0
    v_lshl_add_u32 v7, v4, 3, v7
    v_lshl_add_u32 v7, v2, 8, v7
    ds_read_b64_tr_b16 v[8:9], v7 offset:0
    ds_read_b64_tr_b16 v[10:11], v7 offset:4224
    ds_read_b64_tr_b16 v[12:13], v7 offset:32
    ds_read_b64_tr_b16 v[14:15], v7 offset:4256
    ds_read_b64_tr_b16 v[16:17], v7 offset:64
    ds_read_b64_tr_b16 v[18:19], v7 offset:4288
    ds_read_b64_tr_b16 v[20:21], v7 offset:96
    ds_read_b64_tr_b16 v[22:23], v7 offset:4320
    ds_read_b64_tr_b16 v[24:25], v7 offset:128
    ds_read_b64_tr_b16 v[26:27], v7 offset:4352
    ds_read_b64_tr_b16 v[28:29], v7 offset:160
    ds_read_b64_tr_b16 v[30:31], v7 offset:4384
    ds_read_b64_tr_b16 v[32:33], v7 offset:192
    ds_read_b64_tr_b16 v[34:35], v7 offset:4416
    ds_read_b64_tr_b16 v[36:37], v7 offset:224
    ds_read_b64_tr_b16 v[38:39], v7 offset:4448
    v_mul_u32_u24 v4, 352256, v2
    v_lshl_add_u32 v4, v3, 4, v4
    v_add_u32 v4, s6, v4
    s_waitcnt lgkmcnt(14)
    buffer_store_dwordx4 v[8:11], v4, s[8:11], 0 offen sc1
    v_add_u32 v4, 44032, v4
    s_waitcnt lgkmcnt(12)
    buffer_store_dwordx4 v[12:15], v4, s[8:11], 0 offen sc1
    v_add_u32 v4, 44032, v4
    s_waitcnt lgkmcnt(10)
    buffer_store_dwordx4 v[16:19], v4, s[8:11], 0 offen sc1
    v_add_u32 v4, 44032, v4
    s_waitcnt lgkmcnt(8)
    buffer_store_dwordx4 v[20:23], v4, s[8:11], 0 offen sc1
    v_add_u32 v4, 44032, v4
    s_waitcnt lgkmcnt(6)
    buffer_store_dwordx4 v[24:27], v4, s[8:11], 0 offen sc1
    v_add_u32 v4, 44032, v4
    s_waitcnt lgkmcnt(4)
    buffer_store_dwordx4 v[28:31], v4, s[8:11], 0 offen sc1
    v_add_u32 v4, 44032, v4
    s_waitcnt lgkmcnt(2)
    buffer_store_dwordx4 v[32:35], v4, s[8:11], 0 offen sc1
    v_add_u32 v4, 44032, v4
    s_waitcnt lgkmcnt(0)
    buffer_store_dwordx4 v[36:39], v4, s[8:11], 0 offen sc1
    s_cmp_lg_u32 s3, 41
    s_cbranch_scc1 front_w2_end
    s_waitcnt vmcnt(0) lgkmcnt(0)
    s_barrier
    s_mov_b32 s3, 42
    s_branch front_w2_again
front_w2_end:
    s_endpgm
front_done:
    s_endpgm
front_kernel_end:

.globl conv2_kernel
.p2align 8
.type conv2_kernel,@function
conv2_kernel:
    s_movk_i32 s35, 0x90
    s_movk_i32 s36, 0xd1
    s_movk_i32 s37, 0xb0
    s_movk_i32 s34, 512
conv_body:
    s_load_dwordx2 s[4:5], s[0:1], 120
    s_load_dwordx2 s[6:7], s[0:1], 64
    s_cmp_ge_u32 s2, 512
    s_cbranch_scc1 conv_extra
    s_lshl_b32 s35, s35, 16
    s_lshl_b32 s36, s36, 16
    s_lshl_b32 s37, s37, 16
    s_cmp_ge_u32 s2, 256
    s_cbranch_scc1 conv_lowprio
    s_setprio 2
conv_lowprio:
    v_lshlrev_b32 v1, 4, v0
    v_lshlrev_b32 v2, 6, v0
    v_and_b32 v3, 63, v0
    v_lshlrev_b32 v3, 4, v3
    v_readfirstlane_b32 s24, v0
    s_nop 0
    s_lshr_b32 s24, s24, 6
    s_lshl_b32 s26, s2, 8
    s_mul_i32 s27, s2, 5120
    s_lshr_b32 s28, s2, 1
    s_lshl_b32 s28, s28, 2
    s_waitcnt lgkmcnt(0)
    s_load_dword s29, s[6:7], s28
    s_add_u32 s8, s4, s35
    s_addc_u32 s9, s5, 0
    s_mov_b32 s10, 0x200000
    s_mov_b32 s11, 0x00020000
    s_add_u32 s12, s4, s36
    s_addc_u32 s13, s5, 0
    s_mov_b32 s14, 0x4000
    s_mov_b32 s15, 0x00020000
    s_add_u32 s30, s27, 0x0
    s_add_u32 s16, s4, s30
    s_addc_u32 s17, s5, 0
    s_mov_b32 s18, 5120
    s_mov_b32 s19, 0x00020000
    s_add_u32 s20, s4, s37
    s_addc_u32 s21, s5, 0
    s_mov_b32 s22, 0x200000
    s_mov_b32 s23, 0x00020000
    s_mov_b32 s33, s26
    s_load_dword s32, s[16:17], 4608
    v_lshrrev_b32 v136, 4, v0
    v_lshlrev_b32 v136, 17, v136
    v_and_b32 v1, 15, v0
    v_lshl_add_u32 v136, v1, 4, v136
    buffer_load_dwordx4 v[4:7], v136, s[8:11], s33 offen
    buffer_load_dwordx4 v[16:19], v2, s[12:15], 0 offen offset:0
    buffer_load_dwordx4 v[20:23], v2, s[12:15], 0 offen offset:16
    buffer_load_dwordx4 v[24:27], v2, s[12:15], 0 offen offset:32
    buffer_load_dwordx4 v[28:31], v2, s[12:15], 0 offen offset:48
    s_lshl_b32 s25, s24, 10
    s_add_u32 m0, s25, 512
    s_nop 0
    buffer_load_dwordx4 v3, s[16:19], s25 offen lds
    s_cmp_lg_u32 s24, 0
    s_cbranch_scc1 conv_nok8
    s_mov_b32 s25, 4096
    s_mov_b32 m0, 4608
    s_nop 0
    buffer_load_dwordx4 v3, s[16:19], s25 offen lds
conv_nok8:
    v_mov_b32 v56, 0
    v_mov_b32 v57, 0
    v_mov_b32 v58, 0
    v_mov_b32 v59, 0
    v_lshrrev_b32 v1, 5, v0
    v_and_b32 v2, 31, v0
    v_mul_u32_u24 v1, 4640, v1
    v_cmp_eq_u32 vcc, 20, v2
    v_mov_b32 v3, 276
    s_nop 0
    v_cndmask_b32 v3, v2, v3, vcc
    v_lshl_add_u32 v1, v3, 4, v1
    v_cmp_gt_u32 vcc, 21, v2
    s_nop 0
    s_and_saveexec_b64 s[30:31], vcc
    ds_write_b128 v1, v[56:59] offset:5632
    s_mov_b64 exec, s[30:31]
    v_and_b32 v2, 15, v0
    v_bfe_u32 v3, v0, 4, 2
    v_sub_u32 v144, v3, v2
    v_lshlrev_b32 v144, 4, v144
    s_lshl_b32 s25, s24, 6
    s_sub_u32 s26, 752, s25
    v_add_u32 v144, s26, v144
    v_and_b32 v60, 7, v2
    v_mul_u32_u24 v145, 4640, v60
    v_lshrrev_b32 v61, 3, v2
    v_lshl_add_u32 v145, v61, 8, v145
    v_lshl_add_u32 v145, v3, 4, v145
    s_sub_u32 s26, 5632, s25
    v_add_u32 v145, s26, v145
    v_subrev_u32 v146, 256, v144
    v_subrev_u32 v147, 256, v145
    v_lshlrev_b32 v62, 2, v60
    v_lshl_add_u32 v62, v61, 9, v62
    v_lshl_add_u32 v62, v3, 7, v62
    s_lshl_b32 s25, s24, 13
    v_add_u32 v62, s25, v62
    v_and_b32 v63, 1, v3
    v_lshl_or_b32 v63, v61, 1, v63
    v_xor_b32 v150, 0, v63
    v_lshl_add_u32 v150, v150, 5, v62
    v_xor_b32 v151, 1, v63
    v_lshl_add_u32 v151, v151, 5, v62
    v_xor_b32 v152, 2, v63
    v_lshl_add_u32 v152, v152, 5, v62
    v_xor_b32 v153, 3, v63
    v_lshl_add_u32 v153, v153, 5, v62
    v_bfe_u32 v154, v0, 2, 1
    v_bfe_u32 v3, v0, 4, 1
    v_lshl_or_b32 v154, v3, 1, v154
    v_xor_b32 v154, v154, v0
    v_lshlrev_b32 v154, 5, v154
    v_and_b32 v2, 7, v0
    v_lshrrev_b32 v3, 3, v0
    v_lshlrev_b32 v148, 1, v2
    v_mul_u32_u24 v149, 4638, v3
    v_add_u32 v149, v149, v148
    v_cmp_lt_u32 vcc, v2, v3
    v_cmp_gt_u32 s[42:43], 64, v0
    s_nop 0
    s_and_b64 s[42:43], vcc, s[42:43]
    v_lshlrev_b32 v1, 4, v0
    s_mov_b32 s40, 0x3b000000
    s_mov_b32 s41, 0x3b000000
    s_waitcnt vmcnt(1)
    v_pk_mul_f32 v[16:17], v[16:17], s[40:41]
    v_pk_mul_f32 v[18:19], v[18:19], s[40:41]
    v_pk_mul_f32 v[20:21], v[20:21], s[40:41]
    v_pk_mul_f32 v[22:23], v[22:23], s[40:41]
    v_pk_mul_f32 v[24:25], v[24:25], s[40:41]
    v_pk_mul_f32 v[26:27], v[26:27], s[40:41]
    v_pk_mul_f32 v[28:29], v[28:29], s[40:41]
    v_pk_mul_f32 v[30:31], v[30:31], s[40:41]
    v_fma_f32 v17, -v16, v16, v17
    v_fma_f32 v19, -v18, v18, v19
    v_fma_f32 v21, -v20, v20, v21
    v_fma_f32 v23, -v22, v22, v23
    v_fma_f32 v25, -v24, v24, v25
    v_fma_f32 v27, -v26, v26, v27
    v_fma_f32 v29, -v28, v28, v29
    v_fma_f32 v31, -v30, v30, v31
    v_max_f32 v17, 0, v17
    v_max_f32 v19, 0, v19
    v_max_f32 v21, 0, v21
    v_max_f32 v23, 0, v23
    v_max_f32 v25, 0, v25
    v_max_f32 v27, 0, v27
    v_max_f32 v29, 0, v29
    v_max_f32 v31, 0, v31
    v_cvt_pk_bf16_f32 v16, v16, v17
    v_cvt_pk_bf16_f32 v18, v18, v19
    v_cvt_pk_bf16_f32 v20, v20, v21
    v_cvt_pk_bf16_f32 v22, v22, v23
    v_cvt_pk_bf16_f32 v24, v24, v25
    v_cvt_pk_bf16_f32 v26, v26, v27
    v_cvt_pk_bf16_f32 v28, v28, v29
    v_cvt_pk_bf16_f32 v30, v30, v31
    v_lshlrev_b32 v32, 16, v16
    v_and_b32 v40, 0xffff0000, v16
    v_lshlrev_b32 v33, 16, v18
    v_and_b32 v41, 0xffff0000, v18
    v_lshlrev_b32 v34, 16, v20
    v_and_b32 v42, 0xffff0000, v20
    v_lshlrev_b32 v35, 16, v22
    v_and_b32 v43, 0xffff0000, v22
    v_lshlrev_b32 v36, 16, v24
    v_and_b32 v44, 0xffff0000, v24
    v_lshlrev_b32 v37, 16, v26
    v_and_b32 v45, 0xffff0000, v26
    v_lshlrev_b32 v38, 16, v28
    v_and_b32 v46, 0xffff0000, v28
    v_lshlrev_b32 v39, 16, v30
    v_and_b32 v47, 0xffff0000, v30
    v_mov_b32 v60, 0x3727c5ac
    v_mov_b32 v61, 0x3727c5ac
    v_pk_add_f32 v[40:41], v[40:41], v[60:61]
    v_pk_add_f32 v[42:43], v[42:43], v[60:61]
    v_pk_add_f32 v[44:45], v[44:45], v[60:61]
    v_pk_add_f32 v[46:47], v[46:47], v[60:61]
    v_cvt_pk_bf16_f32 v16, v40, v41
    v_cvt_pk_bf16_f32 v18, v42, v43
    v_cvt_pk_bf16_f32 v20, v44, v45
    v_cvt_pk_bf16_f32 v22, v46, v47
    v_lshlrev_b32 v40, 16, v16
    v_and_b32 v41, 0xffff0000, v16
    v_lshlrev_b32 v42, 16, v18
    v_and_b32 v43, 0xffff0000, v18
    v_lshlrev_b32 v44, 16, v20
    v_and_b32 v45, 0xffff0000, v20
    v_lshlrev_b32 v46, 16, v22
    v_and_b32 v47, 0xffff0000, v22
    v_sqrt_f32 v40, v40
    v_sqrt_f32 v41, v41
    v_sqrt_f32 v42, v42
    v_sqrt_f32 v43, v43
    v_sqrt_f32 v44, v44
    v_sqrt_f32 v45, v45
    v_sqrt_f32 v46, v46
    v_sqrt_f32 v47, v47
    v_cvt_pk_bf16_f32 v16, v40, v41
    v_cvt_pk_bf16_f32 v18, v42, v43
    v_cvt_pk_bf16_f32 v20, v44, v45
    v_cvt_pk_bf16_f32 v22, v46, v47
    v_lshlrev_b32 v40, 16, v16
    v_and_b32 v41, 0xffff0000, v16
    v_lshlrev_b32 v42, 16, v18
    v_and_b32 v43, 0xffff0000, v18
    v_lshlrev_b32 v44, 16, v20
    v_and_b32 v45, 0xffff0000, v20
    v_lshlrev_b32 v46, 16, v22
    v_and_b32 v47, 0xffff0000, v22
    v_rcp_f32 v40, v40
    v_rcp_f32 v41, v41
    v_rcp_f32 v42, v42
    v_rcp_f32 v43, v43
    v_rcp_f32 v44, v44
    v_rcp_f32 v45, v45
    v_rcp_f32 v46, v46
    v_rcp_f32 v47, v47
    v_lshlrev_b32 v48, 16, v4
    v_and_b32 v49, 0xffff0000, v4
    v_lshlrev_b32 v50, 16, v5
    v_and_b32 v51, 0xffff0000, v5
    v_lshlrev_b32 v52, 16, v6
    v_and_b32 v53, 0xffff0000, v6
    v_lshlrev_b32 v54, 16, v7
    v_and_b32 v55, 0xffff0000, v7
    v_pk_add_f32 v[48:49], v[48:49], v[32:33] neg_lo:[0,1] neg_hi:[0,1]
    v_pk_add_f32 v[50:51], v[50:51], v[34:35] neg_lo:[0,1] neg_hi:[0,1]
    v_pk_add_f32 v[52:53], v[52:53], v[36:37] neg_lo:[0,1] neg_hi:[0,1]
    v_pk_add_f32 v[54:55], v[54:55], v[38:39] neg_lo:[0,1] neg_hi:[0,1]
    v_cvt_pk_bf16_f32 v60, v48, v49
    v_lshlrev_b32 v48, 16, v60
    v_and_b32 v49, 0xffff0000, v60
    v_cvt_pk_bf16_f32 v60, v50, v51
    v_lshlrev_b32 v50, 16, v60
    v_and_b32 v51, 0xffff0000, v60
    v_cvt_pk_bf16_f32 v60, v52, v53
    v_lshlrev_b32 v52, 16, v60
    v_and_b32 v53, 0xffff0000, v60
    v_cvt_pk_bf16_f32 v60, v54, v55
    v_lshlrev_b32 v54, 16, v60
    v_and_b32 v55, 0xffff0000, v60
    v_pk_mul_f32 v[48:49], v[48:49], v[40:41]
    v_pk_mul_f32 v[50:51], v[50:51], v[42:43]
    v_pk_mul_f32 v[52:53], v[52:53], v[44:45]
    v_pk_mul_f32 v[54:55], v[54:55], v[46:47]
    v_cvt_pk_bf16_f32 v140, v48, v49
    v_cvt_pk_bf16_f32 v141, v50, v51
    v_cvt_pk_bf16_f32 v142, v52, v53
    v_cvt_pk_bf16_f32 v143, v54, v55
    v_lshlrev_b32 v48, 16, v140
    v_and_b32 v49, 0xffff0000, v140
    v_lshlrev_b32 v50, 16, v141
    v_and_b32 v51, 0xffff0000, v141
    v_lshlrev_b32 v52, 16, v142
    v_and_b32 v53, 0xffff0000, v142
    v_lshlrev_b32 v54, 16, v143
    v_and_b32 v55, 0xffff0000, v143
    v_cvt_pk_f16_f32 v8, v48, v49
    v_cvt_pk_f16_f32 v9, v50, v51
    v_cvt_pk_f16_f32 v10, v52, v53
    v_cvt_pk_f16_f32 v11, v54, v55
    ds_write_b128 v1, v[8:11] offset:5952
    s_waitcnt lgkmcnt(0)
    s_barrier
    ds_read_b128 v[12:15], v1 offset:5968
    ds_read_u16 v58, v148 offset:5952
    s_waitcnt lgkmcnt(0)
    s_and_saveexec_b64 s[30:31], s[42:43]
    ds_write_b16 v149, v58 offset:5952
    s_mov_b64 exec, s[30:31]
    v_alignbit_b32 v16, v9, v8, 16
    v_alignbit_b32 v17, v10, v9, 16
    v_alignbit_b32 v18, v11, v10, 16
    v_alignbit_b32 v19, v12, v11, 16
    ds_write_b128 v1, v[16:19] offset:10592
    v_mov_b32 v20, v9
    v_mov_b32 v21, v10
    v_mov_b32 v22, v11
    v_mov_b32 v23, v12
    ds_write_b128 v1, v[20:23] offset:15232
    v_alignbit_b32 v24, v10, v9, 16
    v_alignbit_b32 v25, v11, v10, 16
    v_alignbit_b32 v26, v12, v11, 16
    v_alignbit_b32 v27, v13, v12, 16
    ds_write_b128 v1, v[24:27] offset:19872
    ds_write_b128 v1, v[10:13] offset:24512
    v_alignbit_b32 v32, v11, v10, 16
    v_alignbit_b32 v33, v12, v11, 16
    v_alignbit_b32 v34, v13, v12, 16
    v_alignbit_b32 v35, v14, v13, 16
    ds_write_b128 v1, v[32:35] offset:29152
    v_mov_b32 v36, v11
    v_mov_b32 v37, v12
    v_mov_b32 v38, v13
    v_mov_b32 v39, v14
    ds_write_b128 v1, v[36:39] offset:33792
    v_alignbit_b32 v40, v12, v11, 16
    v_alignbit_b32 v41, v13, v12, 16
    v_alignbit_b32 v42, v14, v13, 16
    v_alignbit_b32 v43, v15, v14, 16
    ds_write_b128 v1, v[40:43] offset:38432
    s_waitcnt vmcnt(0) lgkmcnt(0)
    s_barrier
    ds_read_b128 v[100:103], v145 offset:512
    ds_read_b128 v[64:67], v144 offset:4096
    ds_read_b128 v[68:71], v144 offset:3584
    ds_read_b128 v[72:75], v144 offset:3072
    ds_read_b128 v[76:79], v144 offset:2560
    ds_read_b128 v[80:83], v144 offset:2048
    ds_read_b128 v[84:87], v144 offset:1536
    ds_read_b128 v[88:91], v144 offset:1024
    s_waitcnt lgkmcnt(7)
    s_waitcnt lgkmcnt(6)
    v_mfma_f32_16x16x32_f16 v[32:35], v[64:67], v[100:103], 0
    ds_read_b128 v[92:95], v144 offset:512
    s_waitcnt lgkmcnt(6)
    v_mfma_f32_16x16x32_f16 v[36:39], v[68:71], v[100:103], 0
    ds_read_b128 v[104:107], v145 offset:1024
    s_waitcnt lgkmcnt(6)
    v_mfma_f32_16x16x32_f16 v[40:43], v[72:75], v[100:103], 0
    ds_read_b128 v[108:111], v145 offset:1536
    s_waitcnt lgkmcnt(6)
    v_mfma_f32_16x16x32_f16 v[44:47], v[76:79], v[100:103], 0
    ds_read_b128 v[112:115], v145 offset:2048
    s_waitcnt lgkmcnt(6)
    v_mfma_f32_16x16x32_f16 v[48:51], v[80:83], v[100:103], 0
    ds_read_b128 v[116:119], v145 offset:2560
    s_waitcnt lgkmcnt(6)
    v_mfma_f32_16x16x32_f16 v[52:55], v[84:87], v[100:103], 0
    ds_read_b128 v[120:123], v145 offset:3072
    s_waitcnt lgkmcnt(6)
    v_mfma_f32_16x16x32_f16 v[56:59], v[88:91], v[100:103], 0
    ds_read_b128 v[124:127], v145 offset:3584
    s_waitcnt lgkmcnt(6)
    v_mfma_f32_16x16x32_f16 v[60:63], v[92:95], v[100:103], 0
    ds_read_b128 v[128:131], v145 offset:4096
    s_waitcnt lgkmcnt(0)
    s_cmp_lg_u32 s24, 0
    s_cbranch_scc1 conv_noext
    ds_read_b128 v[96:99], v144 offset:0
    ds_read_b128 v[132:135], v145 offset:0
    s_waitcnt lgkmcnt(0)
    v_mfma_f32_16x16x32_f16 v[32:35], v[68:71], v[132:135], v[32:35]
    v_mfma_f32_16x16x32_f16 v[36:39], v[72:75], v[132:135], v[36:39]
    v_mfma_f32_16x16x32_f16 v[40:43], v[76:79], v[132:135], v[40:43]
    v_mfma_f32_16x16x32_f16 v[44:47], v[80:83], v[132:135], v[44:47]
    v_mfma_f32_16x16x32_f16 v[48:51], v[84:87], v[132:135], v[48:51]
    v_mfma_f32_16x16x32_f16 v[52:55], v[88:91], v[132:135], v[52:55]
    v_mfma_f32_16x16x32_f16 v[56:59], v[92:95], v[132:135], v[56:59]
    v_mfma_f32_16x16x32_f16 v[60:63], v[96:99], v[132:135], v[60:63]
conv_noext:
    ds_read_b128 v[100:103], v147 offset:512
    ds_read_b128 v[92:95], v146 offset:4096
    v_mfma_f32_16x16x32_f16 v[36:39], v[64:67], v[104:107], v[36:39]
    v_mfma_f32_16x16x32_f16 v[40:43], v[68:71], v[104:107], v[40:43]
    v_mfma_f32_16x16x32_f16 v[44:47], v[72:75], v[104:107], v[44:47]
    v_mfma_f32_16x16x32_f16 v[48:51], v[76:79], v[104:107], v[48:51]
    v_mfma_f32_16x16x32_f16 v[52:55], v[80:83], v[104:107], v[52:55]
    v_mfma_f32_16x16x32_f16 v[56:59], v[84:87], v[104:107], v[56:59]
    v_mfma_f32_16x16x32_f16 v[60:63], v[88:91], v[104:107], v[60:63]
    ds_read_b128 v[104:107], v147 offset:1024
    ds_read_b128 v[88:91], v146 offset:3584
    v_mfma_f32_16x16x32_f16 v[40:43], v[64:67], v[108:111], v[40:43]
    v_mfma_f32_16x16x32_f16 v[44:47], v[68:71], v[108:111], v[44:47]
    v_mfma_f32_16x16x32_f16 v[48:51], v[72:75], v[108:111], v[48:51]
    v_mfma_f32_16x16x32_f16 v[52:55], v[76:79], v[108:111], v[52:55]
    v_mfma_f32_16x16x32_f16 v[56:59], v[80:83], v[108:111], v[56:59]
    v_mfma_f32_16x16x32_f16 v[60:63], v[84:87], v[108:111], v[60:63]
    ds_read_b128 v[108:111], v147 offset:1536
    ds_read_b128 v[84:87], v146 offset:3072
    v_mfma_f32_16x16x32_f16 v[44:47], v[64:67], v[112:115], v[44:47]
    v_mfma_f32_16x16x32_f16 v[48:51], v[68:71], v[112:115], v[48:51]
    v_mfma_f32_16x16x32_f16 v[52:55], v[72:75], v[112:115], v[52:55]
    v_mfma_f32_16x16x32_f16 v[56:59], v[76:79], v[112:115], v[56:59]
    v_mfma_f32_16x16x32_f16 v[60:63], v[80:83], v[112:115], v[60:63]
    ds_read_b128 v[112:115], v147 offset:2048
    ds_read_b128 v[80:83], v146 offset:2560
    v_mfma_f32_16x16x32_f16 v[48:51], v[64:67], v[116:119], v[48:51]
    v_mfma_f32_16x16x32_f16 v[52:55], v[68:71], v[116:119], v[52:55]
    v_mfma_f32_16x16x32_f16 v[56:59], v[72:75], v[116:119], v[56:59]
    v_mfma_f32_16x16x32_f16 v[60:63], v[76:79], v[116:119], v[60:63]
    ds_read_b128 v[116:119], v147 offset:2560
    ds_read_b128 v[76:79], v146 offset:2048
    v_mfma_f32_16x16x32_f16 v[52:55], v[64:67], v[120:123], v[52:55]
    v_mfma_f32_16x16x32_f16 v[56:59], v[68:71], v[120:123], v[56:59]
    v_mfma_f32_16x16x32_f16 v[60:63], v[72:75], v[120:123], v[60:63]
    ds_read_b128 v[120:123], v147 offset:3072
    ds_read_b128 v[72:75], v146 offset:1536
    v_mfma_f32_16x16x32_f16 v[56:59], v[64:67], v[124:127], v[56:59]
    v_mfma_f32_16x16x32_f16 v[60:63], v[68:71], v[124:127], v[60:63]
    ds_read_b128 v[124:127], v147 offset:3584
    ds_read_b128 v[68:71], v146 offset:1024
    v_mfma_f32_16x16x32_f16 v[60:63], v[64:67], v[128:131], v[60:63]
    ds_read_b128 v[128:131], v147 offset:4096
    s_waitcnt lgkmcnt(14)
    ds_read_b128 v[64:67], v146 offset:512
    s_waitcnt lgkmcnt(14)
    v_mfma_f32_16x16x32_f16 v[32:35], v[92:95], v[100:103], v[32:35]
    s_waitcnt lgkmcnt(12)
    v_mfma_f32_16x16x32_f16 v[36:39], v[88:91], v[100:103], v[36:39]
    s_waitcnt lgkmcnt(10)
    v_mfma_f32_16x16x32_f16 v[40:43], v[84:87], v[100:103], v[40:43]
    s_waitcnt lgkmcnt(8)
    v_mfma_f32_16x16x32_f16 v[44:47], v[80:83], v[100:103], v[44:47]
    s_waitcnt lgkmcnt(6)
    v_mfma_f32_16x16x32_f16 v[48:51], v[76:79], v[100:103], v[48:51]
    s_waitcnt lgkmcnt(4)
    v_mfma_f32_16x16x32_f16 v[52:55], v[72:75], v[100:103], v[52:55]
    s_waitcnt lgkmcnt(2)
    v_mfma_f32_16x16x32_f16 v[56:59], v[68:71], v[100:103], v[56:59]
    s_waitcnt lgkmcnt(0)
    v_mfma_f32_16x16x32_f16 v[60:63], v[64:67], v[100:103], v[60:63]
    v_mfma_f32_16x16x32_f16 v[36:39], v[92:95], v[104:107], v[36:39]
    v_mfma_f32_16x16x32_f16 v[40:43], v[88:91], v[104:107], v[40:43]
    v_mfma_f32_16x16x32_f16 v[44:47], v[84:87], v[104:107], v[44:47]
    v_mfma_f32_16x16x32_f16 v[48:51], v[80:83], v[104:107], v[48:51]
    v_mfma_f32_16x16x32_f16 v[52:55], v[76:79], v[104:107], v[52:55]
    v_mfma_f32_16x16x32_f16 v[56:59], v[72:75], v[104:107], v[56:59]
    v_mfma_f32_16x16x32_f16 v[60:63], v[68:71], v[104:107], v[60:63]
    v_mfma_f32_16x16x32_f16 v[40:43], v[92:95], v[108:111], v[40:43]
    v_mfma_f32_16x16x32_f16 v[44:47], v[88:91], v[108:111], v[44:47]
    v_mfma_f32_16x16x32_f16 v[48:51], v[84:87], v[108:111], v[48:51]
    v_mfma_f32_16x16x32_f16 v[52:55], v[80:83], v[108:111], v[52:55]
    v_mfma_f32_16x16x32_f16 v[56:59], v[76:79], v[108:111], v[56:59]
    v_mfma_f32_16x16x32_f16 v[60:63], v[72:75], v[108:111], v[60:63]
    v_mfma_f32_16x16x32_f16 v[44:47], v[92:95], v[112:115], v[44:47]
    v_mfma_f32_16x16x32_f16 v[48:51], v[88:91], v[112:115], v[48:51]
    v_mfma_f32_16x16x32_f16 v[52:55], v[84:87], v[112:115], v[52:55]
    v_mfma_f32_16x16x32_f16 v[56:59], v[80:83], v[112:115], v[56:59]
    v_mfma_f32_16x16x32_f16 v[60:63], v[76:79], v[112:115], v[60:63]
    v_mfma_f32_16x16x32_f16 v[48:51], v[92:95], v[116:119], v[48:51]
    v_mfma_f32_16x16x32_f16 v[52:55], v[88:91], v[116:119], v[52:55]
    v_mfma_f32_16x16x32_f16 v[56:59], v[84:87], v[116:119], v[56:59]
    v_mfma_f32_16x16x32_f16 v[60:63], v[80:83], v[116:119], v[60:63]
    v_mfma_f32_16x16x32_f16 v[52:55], v[92:95], v[120:123], v[52:55]
    v_mfma_f32_16x16x32_f16 v[56:59], v[88:91], v[120:123], v[56:59]
    v_mfma_f32_16x16x32_f16 v[60:63], v[84:87], v[120:123], v[60:63]
    v_mfma_f32_16x16x32_f16 v[56:59], v[92:95], v[124:127], v[56:59]
    v_mfma_f32_16x16x32_f16 v[60:63], v[88:91], v[124:127], v[60:63]
    v_mfma_f32_16x16x32_f16 v[60:63], v[92:95], v[128:131], v[60:63]
    s_barrier
    ds_write_b32 v150, v32 offset:5632
    ds_write_b32 v151, v33 offset:5632
    ds_write_b32 v152, v34 offset:5632
    ds_write_b32 v153, v35 offset:5632
    ds_write_b32 v150, v36 offset:6656
    ds_write_b32 v151, v37 offset:6656
    ds_write_b32 v152, v38 offset:6656
    ds_write_b32 v153, v39 offset:6656
    ds_write_b32 v150, v40 offset:7680
    ds_write_b32 v151, v41 offset:7680
    ds_write_b32 v152, v42 offset:7680
    ds_write_b32 v153, v43 offset:7680
    s_waitcnt lgkmcnt(0)
    ds_write_b32 v150, v44 offset:8704
    ds_write_b32 v151, v45 offset:8704
    ds_write_b32 v152, v46 offset:8704
    ds_write_b32 v153, v47 offset:8704
    ds_write_b32 v150, v48 offset:9728
    ds_write_b32 v151, v49 offset:9728
    ds_write_b32 v152, v50 offset:9728
    ds_write_b32 v153, v51 offset:9728
    ds_write_b32 v150, v52 offset:10752
    ds_write_b32 v151, v53 offset:10752
    ds_write_b32 v152, v54 offset:10752
    ds_write_b32 v153, v55 offset:10752
    s_waitcnt lgkmcnt(0)
    ds_write_b32 v150, v56 offset:11776
    ds_write_b32 v151, v57 offset:11776
    ds_write_b32 v152, v58 offset:11776
    ds_write_b32 v153, v59 offset:11776
    ds_write_b32 v150, v60 offset:12800
    ds_write_b32 v151, v61 offset:12800
    ds_write_b32 v152, v62 offset:12800
    ds_write_b32 v153, v63 offset:12800
    s_waitcnt lgkmcnt(0)
    s_barrier
    ds_read_b128 v[64:67], v154 offset:5632
    ds_read_b128 v[68:71], v154 offset:5648
    ds_read_b128 v[72:75], v154 offset:13824
    ds_read_b128 v[76:79], v154 offset:13840
    ds_read_b128 v[80:83], v154 offset:22016
    ds_read_b128 v[84:87], v154 offset:22032
    ds_read_b128 v[88:91], v154 offset:30208
    ds_read_b128 v[92:95], v154 offset:30224
    s_and_b32 s25, s2, 1
    s_lshl_b32 s25, s25, 4
    s_lshr_b32 s29, s29, s25
    s_lshl_b32 s29, s29, 16
    s_mov_b32 s30, s29
    s_mov_b32 s31, s29
    s_mov_b32 s40, s32
    s_mov_b32 s41, s32
    v_lshlrev_b32 v16, 16, v140
    v_and_b32 v17, 0xffff0000, v140
    v_lshlrev_b32 v18, 16, v141
    v_and_b32 v19, 0xffff0000, v141
    v_lshlrev_b32 v20, 16, v142
    v_and_b32 v21, 0xffff0000, v142
    v_lshlrev_b32 v22, 16, v143
    v_and_b32 v23, 0xffff0000, v143
    v_pk_mul_f32 v[16:17], v[16:17], s[30:31]
    v_pk_mul_f32 v[18:19], v[18:19], s[30:31]
    v_pk_mul_f32 v[20:21], v[20:21], s[30:31]
    v_pk_mul_f32 v[22:23], v[22:23], s[30:31]
    v_cvt_pk_bf16_f32 v56, v16, v17
    v_lshlrev_b32 v16, 16, v56
    v_and_b32 v17, 0xffff0000, v56
    v_cvt_pk_bf16_f32 v56, v18, v19
    v_lshlrev_b32 v18, 16, v56
    v_and_b32 v19, 0xffff0000, v56
    v_cvt_pk_bf16_f32 v56, v20, v21
    v_lshlrev_b32 v20, 16, v56
    v_and_b32 v21, 0xffff0000, v56
    v_cvt_pk_bf16_f32 v56, v22, v23
    v_lshlrev_b32 v22, 16, v56
    v_and_b32 v23, 0xffff0000, v56
    v_lshlrev_b32 v48, 16, v4
    v_and_b32 v49, 0xffff0000, v4
    v_lshlrev_b32 v50, 16, v5
    v_and_b32 v51, 0xffff0000, v5
    v_lshlrev_b32 v52, 16, v6
    v_and_b32 v53, 0xffff0000, v6
    v_lshlrev_b32 v54, 16, v7
    v_and_b32 v55, 0xffff0000, v7
    s_waitcnt lgkmcnt(0)
    v_pk_add_f32 v[64:65], v[64:65], v[72:73]
    v_pk_add_f32 v[80:81], v[80:81], v[88:89]
    v_pk_add_f32 v[66:67], v[66:67], v[74:75]
    v_pk_add_f32 v[82:83], v[82:83], v[90:91]
    v_pk_add_f32 v[68:69], v[68:69], v[76:77]
    v_pk_add_f32 v[84:85], v[84:85], v[92:93]
    v_pk_add_f32 v[70:71], v[70:71], v[78:79]
    v_pk_add_f32 v[86:87], v[86:87], v[94:95]
    v_pk_add_f32 v[64:65], v[64:65], v[80:81]
    v_pk_add_f32 v[66:67], v[66:67], v[82:83]
    v_pk_add_f32 v[68:69], v[68:69], v[84:85]
    v_pk_add_f32 v[70:71], v[70:71], v[86:87]
    v_pk_mul_f32 v[64:65], v[64:65], s[40:41]
    v_pk_mul_f32 v[66:67], v[66:67], s[40:41]
    v_pk_mul_f32 v[68:69], v[68:69], s[40:41]
    v_pk_mul_f32 v[70:71], v[70:71], s[40:41]
    v_cvt_pk_bf16_f32 v56, v64, v65
    v_lshlrev_b32 v64, 16, v56
    v_and_b32 v65, 0xffff0000, v56
    v_cvt_pk_bf16_f32 v56, v66, v67
    v_lshlrev_b32 v66, 16, v56
    v_and_b32 v67, 0xffff0000, v56
    v_cvt_pk_bf16_f32 v56, v68, v69
    v_lshlrev_b32 v68, 16, v56
    v_and_b32 v69, 0xffff0000, v56
    v_cvt_pk_bf16_f32 v56, v70, v71
    v_lshlrev_b32 v70, 16, v56
    v_and_b32 v71, 0xffff0000, v56
    v_pk_add_f32 v[64:65], v[64:65], v[16:17]
    v_pk_add_f32 v[66:67], v[66:67], v[18:19]
    v_pk_add_f32 v[68:69], v[68:69], v[20:21]
    v_pk_add_f32 v[70:71], v[70:71], v[22:23]
    v_cvt_pk_bf16_f32 v56, v64, v65
    v_lshlrev_b32 v64, 16, v56
    v_and_b32 v65, 0xffff0000, v56
    v_cvt_pk_bf16_f32 v56, v66, v67
    v_lshlrev_b32 v66, 16, v56
    v_and_b32 v67, 0xffff0000, v56
    v_cvt_pk_bf16_f32 v56, v68, v69
    v_lshlrev_b32 v68, 16, v56
    v_and_b32 v69, 0xffff0000, v56
    v_cvt_pk_bf16_f32 v56, v70, v71
    v_lshlrev_b32 v70, 16, v56
    v_and_b32 v71, 0xffff0000, v56
    v_pk_add_f32 v[64:65], v[64:65], v[48:49]
    v_pk_add_f32 v[66:67], v[66:67], v[50:51]
    v_pk_add_f32 v[68:69], v[68:69], v[52:53]
    v_pk_add_f32 v[70:71], v[70:71], v[54:55]
    v_cvt_pk_bf16_f32 v56, v64, v65
    v_cvt_pk_bf16_f32 v57, v66, v67
    v_cvt_pk_bf16_f32 v58, v68, v69
    v_cvt_pk_bf16_f32 v59, v70, v71
    buffer_store_dwordx4 v[56:59], v136, s[20:23], s33 offen sc1
conv_done:
    s_endpgm
conv_extra:
    s_cmp_ge_u32 s2, s34
    s_cbranch_scc1 conv_done
    s_endpgm
conv_end:

.globl ffn2_kernel
.p2align 8
.type ffn2_kernel,@function
ffn2_kernel:
    s_mov_b32 s50, 0xb00000
    s_mov_b32 s51, 1
    s_branch ffn_body
.globl ffn1_kernel
.p2align 8
.type ffn1_kernel,@function
ffn1_kernel:
    s_mov_b32 s50, 0x700000
    s_mov_b32 s51, 0
ffn_body:
    s_load_dwordx2 s[4:5], s[0:1], 120
    s_load_dwordx2 s[6:7], s[0:1], 104
    s_cmp_ge_u32 s2, 256
    s_cbranch_scc1 ffn_done
    v_readfirstlane_b32 s47, v0
    s_nop 0
    s_lshr_b32 s47, s47, 6
    s_lshr_b32 s46, s47, 2
    s_and_b32 s24, s47, 3
    s_and_b32 s25, s2, 7
    s_lshr_b32 s26, s2, 3
    s_lshr_b32 s27, s25, 1
    s_lshl_b32 s27, s27, 2
    s_and_b32 s28, s26, 3
    s_add_u32 s27, s27, s28
    s_and_b32 s28, s25, 1
    s_lshl_b32 s28, s28, 3
    s_lshr_b32 s29, s26, 2
    s_add_u32 s28, s28, s29
    s_mul_i32 s29, s28, 11
    s_mul_i32 s30, s24, 3
    s_add_u32 s29, s29, s30
    s_add_u32 s30, s29, 0
    s_lshl_b32 s32, s30, 14
    s_lshl_b32 s40, s30, 6
    s_lshr_b32 s31, s30, 2
    s_lshl_b32 s31, s31, 10
    s_and_b32 s30, s30, 3
    s_lshl_b32 s30, s30, 8
    s_add_u32 s31, s31, s30
    s_mul_i32 s30, s27, 360448
    s_add_u32 s36, s31, s30
    s_add_u32 s30, s29, 1
    s_lshl_b32 s33, s30, 14
    s_lshl_b32 s41, s30, 6
    s_lshr_b32 s31, s30, 2
    s_lshl_b32 s31, s31, 10
    s_and_b32 s30, s30, 3
    s_lshl_b32 s30, s30, 8
    s_add_u32 s31, s31, s30
    s_mul_i32 s30, s27, 360448
    s_add_u32 s37, s31, s30
    s_add_u32 s30, s29, 2
    s_lshl_b32 s34, s30, 14
    s_lshl_b32 s42, s30, 6
    s_lshr_b32 s31, s30, 2
    s_lshl_b32 s31, s31, 10
    s_and_b32 s30, s30, 3
    s_lshl_b32 s30, s30, 8
    s_add_u32 s31, s31, s30
    s_mul_i32 s30, s27, 360448
    s_add_u32 s38, s31, s30
    s_cmp_eq_u32 s24, 3
    s_cselect_b32 s34, 0x2c0000, s34
    s_cselect_b32 s38, 0x40000000, s38
    s_cselect_b32 s42, 0x40000000, s42
    s_lshl_b32 s30, s46, 10
    s_add_u32 s32, s32, s30
    s_add_u32 s33, s33, s30
    s_sub_u32 s33, s33, 1024
    s_add_u32 s34, s34, s30
    s_sub_u32 s34, s34, 2048
    v_and_b32 v3, 63, v0
    v_lshlrev_b32 v1, 4, v3
    v_lshrrev_b32 v4, 4, v3
    v_and_b32 v5, 15, v3
    s_and_b32 s30, s47, 1
    s_lshl_b32 s30, s30, 3
    v_lshlrev_b32 v6, 1, v4
    v_or_b32 v6, s30, v6
    v_xor_b32 v6, v6, v5
    v_lshlrev_b32 v6, 4, v6
    v_lshl_add_u32 v2, v4, 8, v6
    s_lshl_b32 s44, s47, 11
    s_lshl_b32 s31, s27, 17
    s_add_u32 s30, s44, s31
    v_add_u32 v2, s30, v2
    s_mul_i32 s45, s46, 12288
    s_mul_i32 s30, s24, 3072
    s_add_u32 s45, s45, s30
    s_add_u32 s45, s45, 16384
    s_mul_i32 s30, s51, 6291456
    s_add_u32 s30, s30, 19922944
    s_waitcnt lgkmcnt(0)
    s_add_u32 s8, s4, s50
    s_addc_u32 s9, s5, 0
    s_mov_b32 s10, 0x200000
    s_mov_b32 s11, 0x00020000
    s_add_u32 s12, s4, 0xe00000
    s_addc_u32 s13, s5, 0
    s_mov_b32 s14, 0x2c4000
    s_mov_b32 s15, 0x00020000
    s_add_u32 s20, s4, s30
    s_addc_u32 s21, s5, 0
    s_mov_b32 s22, 0x580000
    s_mov_b32 s23, 0x00020000
    s_add_u32 m0, s44, 0
    s_mov_b32 s48, 0
    buffer_load_dwordx4 v2, s[8:11], s48 offen offset:0 lds
    buffer_load_dwordx4 v2, s[8:11], s48 offen offset:1024 lds
    s_add_u32 m0, s45, 0
    s_nop 0
    buffer_load_dwordx4 v1, s[12:15], s32 offen offset:0 lds
    buffer_load_dwordx4 v1, s[12:15], s33 offen offset:1024 lds
    buffer_load_dwordx4 v1, s[12:15], s34 offen offset:2048 lds
    s_add_u32 m0, s44, 40960
    s_mov_b32 s48, 16384
    buffer_load_dwordx4 v2, s[8:11], s48 offen offset:0 lds
    buffer_load_dwordx4 v2, s[8:11], s48 offen offset:1024 lds
    s_add_u32 m0, s45, 40960
    s_add_u32 s32, s32, 2048
    buffer_load_dwordx4 v1, s[12:15], s32 offen offset:0 lds
    s_add_u32 s33, s33, 2048
    buffer_load_dwordx4 v1, s[12:15], s33 offen offset:1024 lds
    s_add_u32 s34, s34, 2048
    buffer_load_dwordx4 v1, s[12:15], s34 offen offset:2048 lds
    s_add_u32 s16, s4, 0xd20000
    s_addc_u32 s17, s5, 0
    s_mov_b32 s18, 0x5800
    s_mov_b32 s19, 0x00020000
    s_add_u32 s60, s4, 0x1100000
    s_addc_u32 s61, s5, 0
    s_mov_b32 s62, 0x158000
    s_mov_b32 s63, 0x00020000
    s_add_u32 s64, s4, 0xd40000
    s_addc_u32 s65, s5, 0
    s_mov_b32 s66, 0x10000
    s_mov_b32 s67, 0x00020000
    s_lshr_b32 s26, s28, 1
    s_lshl_b32 s30, s26, 2
    s_add_u32 s30, s30, s24
    s_mul_i32 s68, s30, 44032
    s_lshl_b32 s30, s46, 10
    s_add_u32 s68, s68, s30
    s_lshl_b32 s69, s46, 12
    s_lshl_b32 s30, s24, 10
    s_add_u32 s69, s69, s30
    s_add_u32 s69, s69, 10240
    v_lshrrev_b32 v6, 2, v5
    v_and_b32 v7, 1, v4
    v_lshlrev_b32 v7, 3, v7
    v_lshl_or_b32 v7, v6, 1, v7
    v_lshlrev_b32 v7, 4, v7
    v_lshl_add_u32 v6, v4, 3, v6
    v_lshlrev_b32 v6, 8, v6
    v_and_b32 v18, 3, v3
    v_lshl_add_u32 v6, v18, 3, v6
    s_lshl_b32 s49, s46, 2
    s_add_u32 s30, s24, 0
    s_and_b32 s30, s30, 3
    s_add_u32 s30, s30, s49
    s_lshl_b32 s30, s30, 5
    v_xor_b32 v8, s30, v7
    v_add_u32 v8, v8, v6
    v_add_u32 v12, 81920, v8
    s_add_u32 s30, s24, 1
    s_and_b32 s30, s30, 3
    s_add_u32 s30, s30, s49
    s_lshl_b32 s30, s30, 5
    v_xor_b32 v9, s30, v7
    v_add_u32 v9, v9, v6
    v_add_u32 v13, 81920, v9
    s_add_u32 s30, s24, 2
    s_and_b32 s30, s30, 3
    s_add_u32 s30, s30, s49
    s_lshl_b32 s30, s30, 5
    v_xor_b32 v10, s30, v7
    v_add_u32 v10, v10, v6
    v_add_u32 v14, 81920, v10
    s_add_u32 s30, s24, 3
    s_and_b32 s30, s30, 3
    s_add_u32 s30, s30, s49
    s_lshl_b32 s30, s30, 5
    v_xor_b32 v11, s30, v7
    v_add_u32 v11, v11, v6
    v_add_u32 v15, 81920, v11
    s_mul_i32 s30, s24, 3072
    s_add_u32 s30, s30, 16384
    v_add_u32 v16, s30, v1
    v_add_u32 v17, 81920, v16
    s_waitcnt vmcnt(5)
    s_barrier
    ds_read_b128 v[96:99], v16 offset:0
    ds_read_b128 v[100:103], v16 offset:1024
    ds_read_b128 v[104:107], v16 offset:2048
    ds_read_b64_tr_b16 v[120:121], v8 offset:0
    ds_read_b64_tr_b16 v[122:123], v8 offset:1024
    ds_read_b64_tr_b16 v[124:125], v9 offset:0
    ds_read_b64_tr_b16 v[126:127], v9 offset:1024
    ds_read_b64_tr_b16 v[128:129], v10 offset:0
    ds_read_b64_tr_b16 v[130:131], v10 offset:1024
    ds_read_b64_tr_b16 v[132:133], v11 offset:0
    ds_read_b64_tr_b16 v[134:135], v11 offset:1024
    s_add_u32 m0, s44, 81920
    s_mov_b32 s48, 32768
    buffer_load_dwordx4 v2, s[8:11], s48 offen offset:0 lds
    buffer_load_dwordx4 v2, s[8:11], s48 offen offset:1024 lds
    s_add_u32 m0, s45, 81920
    s_add_u32 s32, s32, 2048
    buffer_load_dwordx4 v1, s[12:15], s32 offen offset:0 lds
    s_add_u32 s33, s33, 2048
    buffer_load_dwordx4 v1, s[12:15], s33 offen offset:1024 lds
    s_add_u32 s34, s34, 2048
    buffer_load_dwordx4 v1, s[12:15], s34 offen offset:2048 lds
    s_add_u32 m0, s44, 122880
    s_mov_b32 s48, 49152
    buffer_load_dwordx4 v2, s[8:11], s48 offen offset:0 lds
    buffer_load_dwordx4 v2, s[8:11], s48 offen offset:1024 lds
    s_add_u32 m0, s45, 122880
    s_add_u32 s32, s32, 2048
    buffer_load_dwordx4 v1, s[12:15], s32 offen offset:0 lds
    s_add_u32 s33, s33, 2048
    buffer_load_dwordx4 v1, s[12:15], s33 offen offset:1024 lds
    s_add_u32 s34, s34, 2048
    buffer_load_dwordx4 v1, s[12:15], s34 offen offset:2048 lds
    v_lshlrev_b32 v6, 4, v4
    v_add_u32 v7, 11264, v6
    s_waitcnt lgkmcnt(6)
    v_mfma_f32_16x16x32_bf16 v[48:51], v[96:99], v[120:123], 0
    ds_read_b128 v[108:111], v16 offset:12288
    v_mfma_f32_16x16x32_bf16 v[64:67], v[100:103], v[120:123], 0
    ds_read_b128 v[112:115], v16 offset:13312
    v_mfma_f32_16x16x32_bf16 v[80:83], v[104:107], v[120:123], 0
    ds_read_b128 v[116:119], v16 offset:14336
    v_mfma_f32_16x16x32_bf16 v[20:23], v[120:123], v[120:123], 0
    s_waitcnt lgkmcnt(7)
    v_mfma_f32_16x16x32_bf16 v[52:55], v[96:99], v[124:127], 0
    ds_read_b64_tr_b16 v[136:137], v8 offset:8192
    ds_read_b64_tr_b16 v[138:139], v8 offset:9216
    v_mfma_f32_16x16x32_bf16 v[68:71], v[100:103], v[124:127], 0
    ds_read_b64_tr_b16 v[140:141], v9 offset:8192
    ds_read_b64_tr_b16 v[142:143], v9 offset:9216
    v_mfma_f32_16x16x32_bf16 v[84:87], v[104:107], v[124:127], 0
    ds_read_b64_tr_b16 v[144:145], v10 offset:8192
    ds_read_b64_tr_b16 v[146:147], v10 offset:9216
    s_waitcnt lgkmcnt(11)
    v_mfma_f32_16x16x32_bf16 v[56:59], v[96:99], v[128:131], 0
    ds_read_b64_tr_b16 v[148:149], v11 offset:8192
    ds_read_b64_tr_b16 v[150:151], v11 offset:9216
    v_mfma_f32_16x16x32_bf16 v[72:75], v[100:103], v[128:131], 0
    v_mfma_f32_16x16x32_bf16 v[88:91], v[104:107], v[128:131], 0
    s_waitcnt lgkmcnt(11)
    v_mfma_f32_16x16x32_bf16 v[60:63], v[96:99], v[132:135], 0
    v_mfma_f32_16x16x32_bf16 v[76:79], v[100:103], v[132:135], 0
    v_mfma_f32_16x16x32_bf16 v[92:95], v[104:107], v[132:135], 0
    s_waitcnt lgkmcnt(0)
    s_waitcnt vmcnt(10)
    s_barrier
    v_mfma_f32_16x16x32_bf16 v[48:51], v[108:111], v[136:139], v[48:51]
    ds_read_b128 v[96:99], v16 offset:40960
    v_mfma_f32_16x16x32_bf16 v[64:67], v[112:115], v[136:139], v[64:67]
    ds_read_b128 v[100:103], v16 offset:41984
    v_mfma_f32_16x16x32_bf16 v[80:83], v[116:119], v[136:139], v[80:83]
    ds_read_b128 v[104:107], v16 offset:43008
    v_mfma_f32_16x16x32_bf16 v[20:23], v[136:139], v[136:139], v[20:23]
    v_mfma_f32_16x16x32_bf16 v[52:55], v[108:111], v[140:143], v[52:55]
    ds_read_b64_tr_b16 v[120:121], v8 offset:40960
    ds_read_b64_tr_b16 v[122:123], v8 offset:41984
    v_mfma_f32_16x16x32_bf16 v[68:71], v[112:115], v[140:143], v[68:71]
    ds_read_b64_tr_b16 v[124:125], v9 offset:40960
    ds_read_b64_tr_b16 v[126:127], v9 offset:41984
    v_mfma_f32_16x16x32_bf16 v[84:87], v[116:119], v[140:143], v[84:87]
    ds_read_b64_tr_b16 v[128:129], v10 offset:40960
    ds_read_b64_tr_b16 v[130:131], v10 offset:41984
    v_mfma_f32_16x16x32_bf16 v[56:59], v[108:111], v[144:147], v[56:59]
    ds_read_b64_tr_b16 v[132:133], v11 offset:40960
    ds_read_b64_tr_b16 v[134:135], v11 offset:41984
    v_mfma_f32_16x16x32_bf16 v[72:75], v[112:115], v[144:147], v[72:75]
    s_add_u32 m0, s44, 0
    s_mov_b32 s48, 65536
    buffer_load_dwordx4 v2, s[8:11], s48 offen offset:0 lds
    v_mfma_f32_16x16x32_bf16 v[88:91], v[116:119], v[144:147], v[88:91]
    buffer_load_dwordx4 v2, s[8:11], s48 offen offset:1024 lds
    v_mfma_f32_16x16x32_bf16 v[60:63], v[108:111], v[148:151], v[60:63]
    s_add_u32 m0, s45, 0
    s_add_u32 s32, s32, 2048
    buffer_load_dwordx4 v1, s[12:15], s32 offen offset:0 lds
    v_mfma_f32_16x16x32_bf16 v[76:79], v[112:115], v[148:151], v[76:79]
    s_add_u32 s33, s33, 2048
    buffer_load_dwordx4 v1, s[12:15], s33 offen offset:1024 lds
    v_mfma_f32_16x16x32_bf16 v[92:95], v[116:119], v[148:151], v[92:95]
    s_add_u32 s34, s34, 2048
    buffer_load_dwordx4 v1, s[12:15], s34 offen offset:2048 lds
    s_waitcnt lgkmcnt(6)
    v_mfma_f32_16x16x32_bf16 v[48:51], v[96:99], v[120:123], v[48:51]
    ds_read_b128 v[108:111], v16 offset:53248
    v_mfma_f32_16x16x32_bf16 v[64:67], v[100:103], v[120:123], v[64:67]
    ds_read_b128 v[112:115], v16 offset:54272
    v_mfma_f32_16x16x32_bf16 v[80:83], v[104:107], v[120:123], v[80:83]
    ds_read_b128 v[116:119], v16 offset:55296
    v_mfma_f32_16x16x32_bf16 v[20:23], v[120:123], v[120:123], v[20:23]
    s_waitcnt lgkmcnt(7)
    v_mfma_f32_16x16x32_bf16 v[52:55], v[96:99], v[124:127], v[52:55]
    ds_read_b64_tr_b16 v[136:137], v8 offset:49152
    ds_read_b64_tr_b16 v[138:139], v8 offset:50176
    v_mfma_f32_16x16x32_bf16 v[68:71], v[100:103], v[124:127], v[68:71]
    ds_read_b64_tr_b16 v[140:141], v9 offset:49152
    ds_read_b64_tr_b16 v[142:143], v9 offset:50176
    v_mfma_f32_16x16x32_bf16 v[84:87], v[104:107], v[124:127], v[84:87]
    ds_read_b64_tr_b16 v[144:145], v10 offset:49152
    ds_read_b64_tr_b16 v[146:147], v10 offset:50176
    s_waitcnt lgkmcnt(11)
    v_mfma_f32_16x16x32_bf16 v[56:59], v[96:99], v[128:131], v[56:59]
    ds_read_b64_tr_b16 v[148:149], v11 offset:49152
    ds_read_b64_tr_b16 v[150:151], v11 offset:50176
    v_mfma_f32_16x16x32_bf16 v[72:75], v[100:103], v[128:131], v[72:75]
    v_mfma_f32_16x16x32_bf16 v[88:91], v[104:107], v[128:131], v[88:91]
    s_waitcnt lgkmcnt(11)
    v_mfma_f32_16x16x32_bf16 v[60:63], v[96:99], v[132:135], v[60:63]
    v_mfma_f32_16x16x32_bf16 v[76:79], v[100:103], v[132:135], v[76:79]
    v_mfma_f32_16x16x32_bf16 v[92:95], v[104:107], v[132:135], v[92:95]
    s_waitcnt lgkmcnt(0)
    s_waitcnt vmcnt(10)
    s_barrier
    v_mfma_f32_16x16x32_bf16 v[48:51], v[108:111], v[136:139], v[48:51]
    ds_read_b128 v[96:99], v17 offset:0
    v_mfma_f32_16x16x32_bf16 v[64:67], v[112:115], v[136:139], v[64:67]
    ds_read_b128 v[100:103], v17 offset:1024
    v_mfma_f32_16x16x32_bf16 v[80:83], v[116:119], v[136:139], v[80:83]
    ds_read_b128 v[104:107], v17 offset:2048
    v_mfma_f32_16x16x32_bf16 v[20:23], v[136:139], v[136:139], v[20:23]
    v_mfma_f32_16x16x32_bf16 v[52:55], v[108:111], v[140:143], v[52:55]
    ds_read_b64_tr_b16 v[120:121], v12 offset:0
    ds_read_b64_tr_b16 v[122:123], v12 offset:1024
    v_mfma_f32_16x16x32_bf16 v[68:71], v[112:115], v[140:143], v[68:71]
    ds_read_b64_tr_b16 v[124:125], v13 offset:0
    ds_read_b64_tr_b16 v[126:127], v13 offset:1024
    v_mfma_f32_16x16x32_bf16 v[84:87], v[116:119], v[140:143], v[84:87]
    ds_read_b64_tr_b16 v[128:129], v14 offset:0
    ds_read_b64_tr_b16 v[130:131], v14 offset:1024
    v_mfma_f32_16x16x32_bf16 v[56:59], v[108:111], v[144:147], v[56:59]
    ds_read_b64_tr_b16 v[132:133], v15 offset:0
    ds_read_b64_tr_b16 v[134:135], v15 offset:1024
    v_mfma_f32_16x16x32_bf16 v[72:75], v[112:115], v[144:147], v[72:75]
    s_add_u32 m0, s44, 40960
    s_mov_b32 s48, 81920
    buffer_load_dwordx4 v2, s[8:11], s48 offen offset:0 lds
    v_mfma_f32_16x16x32_bf16 v[88:91], v[116:119], v[144:147], v[88:91]
    buffer_load_dwordx4 v2, s[8:11], s48 offen offset:1024 lds
    v_mfma_f32_16x16x32_bf16 v[60:63], v[108:111], v[148:151], v[60:63]
    s_add_u32 m0, s45, 40960
    s_add_u32 s32, s32, 2048
    buffer_load_dwordx4 v1, s[12:15], s32 offen offset:0 lds
    v_mfma_f32_16x16x32_bf16 v[76:79], v[112:115], v[148:151], v[76:79]
    s_add_u32 s33, s33, 2048
    buffer_load_dwordx4 v1, s[12:15], s33 offen offset:1024 lds
    v_mfma_f32_16x16x32_bf16 v[92:95], v[116:119], v[148:151], v[92:95]
    s_add_u32 s34, s34, 2048
    buffer_load_dwordx4 v1, s[12:15], s34 offen offset:2048 lds
    s_waitcnt lgkmcnt(6)
    v_mfma_f32_16x16x32_bf16 v[48:51], v[96:99], v[120:123], v[48:51]
    ds_read_b128 v[108:111], v17 offset:12288
    v_mfma_f32_16x16x32_bf16 v[64:67], v[100:103], v[120:123], v[64:67]
    ds_read_b128 v[112:115], v17 offset:13312
    v_mfma_f32_16x16x32_bf16 v[80:83], v[104:107], v[120:123], v[80:83]
    ds_read_b128 v[116:119], v17 offset:14336
    v_mfma_f32_16x16x32_bf16 v[20:23], v[120:123], v[120:123], v[20:23]
    s_waitcnt lgkmcnt(7)
    v_mfma_f32_16x16x32_bf16 v[52:55], v[96:99], v[124:127], v[52:55]
    ds_read_b64_tr_b16 v[136:137], v12 offset:8192
    ds_read_b64_tr_b16 v[138:139], v12 offset:9216
    v_mfma_f32_16x16x32_bf16 v[68:71], v[100:103], v[124:127], v[68:71]
    ds_read_b64_tr_b16 v[140:141], v13 offset:8192
    ds_read_b64_tr_b16 v[142:143], v13 offset:9216
    v_mfma_f32_16x16x32_bf16 v[84:87], v[104:107], v[124:127], v[84:87]
    ds_read_b64_tr_b16 v[144:145], v14 offset:8192
    ds_read_b64_tr_b16 v[146:147], v14 offset:9216
    s_waitcnt lgkmcnt(11)
    v_mfma_f32_16x16x32_bf16 v[56:59], v[96:99], v[128:131], v[56:59]
    ds_read_b64_tr_b16 v[148:149], v15 offset:8192
    ds_read_b64_tr_b16 v[150:151], v15 offset:9216
    v_mfma_f32_16x16x32_bf16 v[72:75], v[100:103], v[128:131], v[72:75]
    v_mfma_f32_16x16x32_bf16 v[88:91], v[104:107], v[128:131], v[88:91]
    s_waitcnt lgkmcnt(11)
    v_mfma_f32_16x16x32_bf16 v[60:63], v[96:99], v[132:135], v[60:63]
    v_mfma_f32_16x16x32_bf16 v[76:79], v[100:103], v[132:135], v[76:79]
    v_mfma_f32_16x16x32_bf16 v[92:95], v[104:107], v[132:135], v[92:95]
    s_waitcnt lgkmcnt(0)
    s_waitcnt vmcnt(10)
    s_barrier
    v_mfma_f32_16x16x32_bf16 v[48:51], v[108:111], v[136:139], v[48:51]
    ds_read_b128 v[96:99], v17 offset:40960
    v_mfma_f32_16x16x32_bf16 v[64:67], v[112:115], v[136:139], v[64:67]
    ds_read_b128 v[100:103], v17 offset:41984
    v_mfma_f32_16x16x32_bf16 v[80:83], v[116:119], v[136:139], v[80:83]
    ds_read_b128 v[104:107], v17 offset:43008
    v_mfma_f32_16x16x32_bf16 v[20:23], v[136:139], v[136:139], v[20:23]
    v_mfma_f32_16x16x32_bf16 v[52:55], v[108:111], v[140:143], v[52:55]
    ds_read_b64_tr_b16 v[120:121], v12 offset:40960
    ds_read_b64_tr_b16 v[122:123], v12 offset:41984
    v_mfma_f32_16x16x32_bf16 v[68:71], v[112:115], v[140:143], v[68:71]
    ds_read_b64_tr_b16 v[124:125], v13 offset:40960
    ds_read_b64_tr_b16 v[126:127], v13 offset:41984
    v_mfma_f32_16x16x32_bf16 v[84:87], v[116:119], v[140:143], v[84:87]
    ds_read_b64_tr_b16 v[128:129], v14 offset:40960
    ds_read_b64_tr_b16 v[130:131], v14 offset:41984
    v_mfma_f32_16x16x32_bf16 v[56:59], v[108:111], v[144:147], v[56:59]
    ds_read_b64_tr_b16 v[132:133], v15 offset:40960
    ds_read_b64_tr_b16 v[134:135], v15 offset:41984
    v_mfma_f32_16x16x32_bf16 v[72:75], v[112:115], v[144:147], v[72:75]
    s_add_u32 m0, s44, 81920
    s_mov_b32 s48, 98304
    buffer_load_dwordx4 v2, s[8:11], s48 offen offset:0 lds
    v_mfma_f32_16x16x32_bf16 v[88:91], v[116:119], v[144:147], v[88:91]
    buffer_load_dwordx4 v2, s[8:11], s48 offen offset:1024 lds
    v_mfma_f32_16x16x32_bf16 v[60:63], v[108:111], v[148:151], v[60:63]
    s_add_u32 m0, s45, 81920
    s_add_u32 s32, s32, 2048
    buffer_load_dwordx4 v1, s[12:15], s32 offen offset:0 lds
    v_mfma_f32_16x16x32_bf16 v[76:79], v[112:115], v[148:151], v[76:79]
    s_add_u32 s33, s33, 2048
    buffer_load_dwordx4 v1, s[12:15], s33 offen offset:1024 lds
    v_mfma_f32_16x16x32_bf16 v[92:95], v[116:119], v[148:151], v[92:95]
    s_add_u32 s34, s34, 2048
    buffer_load_dwordx4 v1, s[12:15], s34 offen offset:2048 lds
    s_waitcnt lgkmcnt(6)
    v_mfma_f32_16x16x32_bf16 v[48:51], v[96:99], v[120:123], v[48:51]
    ds_read_b128 v[108:111], v17 offset:53248
    v_mfma_f32_16x16x32_bf16 v[64:67], v[100:103], v[120:123], v[64:67]
    ds_read_b128 v[112:115], v17 offset:54272
    v_mfma_f32_16x16x32_bf16 v[80:83], v[104:107], v[120:123], v[80:83]
    ds_read_b128 v[116:119], v17 offset:55296
    v_mfma_f32_16x16x32_bf16 v[20:23], v[120:123], v[120:123], v[20:23]
    s_waitcnt lgkmcnt(7)
    v_mfma_f32_16x16x32_bf16 v[52:55], v[96:99], v[124:127], v[52:55]
    ds_read_b64_tr_b16 v[136:137], v12 offset:49152
    ds_read_b64_tr_b16 v[138:139], v12 offset:50176
    v_mfma_f32_16x16x32_bf16 v[68:71], v[100:103], v[124:127], v[68:71]
    ds_read_b64_tr_b16 v[140:141], v13 offset:49152
    ds_read_b64_tr_b16 v[142:143], v13 offset:50176
    v_mfma_f32_16x16x32_bf16 v[84:87], v[104:107], v[124:127], v[84:87]
    ds_read_b64_tr_b16 v[144:145], v14 offset:49152
    ds_read_b64_tr_b16 v[146:147], v14 offset:50176
    s_waitcnt lgkmcnt(11)
    v_mfma_f32_16x16x32_bf16 v[56:59], v[96:99], v[128:131], v[56:59]
    ds_read_b64_tr_b16 v[148:149], v15 offset:49152
    ds_read_b64_tr_b16 v[150:151], v15 offset:50176
    v_mfma_f32_16x16x32_bf16 v[72:75], v[100:103], v[128:131], v[72:75]
    v_mfma_f32_16x16x32_bf16 v[88:91], v[104:107], v[128:131], v[88:91]
    s_waitcnt lgkmcnt(11)
    v_mfma_f32_16x16x32_bf16 v[60:63], v[96:99], v[132:135], v[60:63]
    v_mfma_f32_16x16x32_bf16 v[76:79], v[100:103], v[132:135], v[76:79]
    v_mfma_f32_16x16x32_bf16 v[92:95], v[104:107], v[132:135], v[92:95]
    s_waitcnt lgkmcnt(0)
    s_waitcnt vmcnt(10)
    s_barrier
    v_mfma_f32_16x16x32_bf16 v[48:51], v[108:111], v[136:139], v[48:51]
    ds_read_b128 v[96:99], v16 offset:0
    v_mfma_f32_16x16x32_bf16 v[64:67], v[112:115], v[136:139], v[64:67]
    ds_read_b128 v[100:103], v16 offset:1024
    v_mfma_f32_16x16x32_bf16 v[80:83], v[116:119], v[136:139], v[80:83]
    ds_read_b128 v[104:107], v16 offset:2048
    v_mfma_f32_16x16x32_bf16 v[20:23], v[136:139], v[136:139], v[20:23]
    v_mfma_f32_16x16x32_bf16 v[52:55], v[108:111], v[140:143], v[52:55]
    ds_read_b64_tr_b16 v[120:121], v8 offset:0
    ds_read_b64_tr_b16 v[122:123], v8 offset:1024
    v_mfma_f32_16x16x32_bf16 v[68:71], v[112:115], v[140:143], v[68:71]
    ds_read_b64_tr_b16 v[124:125], v9 offset:0
    ds_read_b64_tr_b16 v[126:127], v9 offset:1024
    v_mfma_f32_16x16x32_bf16 v[84:87], v[116:119], v[140:143], v[84:87]
    ds_read_b64_tr_b16 v[128:129], v10 offset:0
    ds_read_b64_tr_b16 v[130:131], v10 offset:1024
    v_mfma_f32_16x16x32_bf16 v[56:59], v[108:111], v[144:147], v[56:59]
    ds_read_b64_tr_b16 v[132:133], v11 offset:0
    ds_read_b64_tr_b16 v[134:135], v11 offset:1024
    v_mfma_f32_16x16x32_bf16 v[72:75], v[112:115], v[144:147], v[72:75]
    s_add_u32 m0, s44, 122880
    s_mov_b32 s48, 114688
    buffer_load_dwordx4 v2, s[8:11], s48 offen offset:0 lds
    v_mfma_f32_16x16x32_bf16 v[88:91], v[116:119], v[144:147], v[88:91]
    buffer_load_dwordx4 v2, s[8:11], s48 offen offset:1024 lds
    v_mfma_f32_16x16x32_bf16 v[60:63], v[108:111], v[148:151], v[60:63]
    s_add_u32 m0, s45, 122880
    s_add_u32 s32, s32, 2048
    buffer_load_dwordx4 v1, s[12:15], s32 offen offset:0 lds
    v_mfma_f32_16x16x32_bf16 v[76:79], v[112:115], v[148:151], v[76:79]
    s_add_u32 s33, s33, 2048
    buffer_load_dwordx4 v1, s[12:15], s33 offen offset:1024 lds
    v_mfma_f32_16x16x32_bf16 v[92:95], v[116:119], v[148:151], v[92:95]
    s_add_u32 s34, s34, 2048
    buffer_load_dwordx4 v1, s[12:15], s34 offen offset:2048 lds
    s_waitcnt lgkmcnt(6)
    v_mfma_f32_16x16x32_bf16 v[48:51], v[96:99], v[120:123], v[48:51]
    ds_read_b128 v[108:111], v16 offset:12288
    v_mfma_f32_16x16x32_bf16 v[64:67], v[100:103], v[120:123], v[64:67]
    ds_read_b128 v[112:115], v16 offset:13312
    v_mfma_f32_16x16x32_bf16 v[80:83], v[104:107], v[120:123], v[80:83]
    ds_read_b128 v[116:119], v16 offset:14336
    v_mfma_f32_16x16x32_bf16 v[20:23], v[120:123], v[120:123], v[20:23]
    s_waitcnt lgkmcnt(7)
    v_mfma_f32_16x16x32_bf16 v[52:55], v[96:99], v[124:127], v[52:55]
    ds_read_b64_tr_b16 v[136:137], v8 offset:8192
    ds_read_b64_tr_b16 v[138:139], v8 offset:9216
    v_mfma_f32_16x16x32_bf16 v[68:71], v[100:103], v[124:127], v[68:71]
    ds_read_b64_tr_b16 v[140:141], v9 offset:8192
    ds_read_b64_tr_b16 v[142:143], v9 offset:9216
    v_mfma_f32_16x16x32_bf16 v[84:87], v[104:107], v[124:127], v[84:87]
    ds_read_b64_tr_b16 v[144:145], v10 offset:8192
    ds_read_b64_tr_b16 v[146:147], v10 offset:9216
    s_waitcnt lgkmcnt(11)
    v_mfma_f32_16x16x32_bf16 v[56:59], v[96:99], v[128:131], v[56:59]
    ds_read_b64_tr_b16 v[148:149], v11 offset:8192
    ds_read_b64_tr_b16 v[150:151], v11 offset:9216
    v_mfma_f32_16x16x32_bf16 v[72:75], v[100:103], v[128:131], v[72:75]
    buffer_load_dwordx4 v[24:27], v6, s[16:19], s40 offen
    buffer_load_dwordx4 v[36:39], v7, s[16:19], s40 offen
    v_mfma_f32_16x16x32_bf16 v[88:91], v[104:107], v[128:131], v[88:91]
    buffer_load_dwordx4 v[28:31], v6, s[16:19], s41 offen
    buffer_load_dwordx4 v[40:43], v7, s[16:19], s41 offen
    s_waitcnt lgkmcnt(11)
    v_mfma_f32_16x16x32_bf16 v[60:63], v[96:99], v[132:135], v[60:63]
    buffer_load_dwordx4 v[32:35], v6, s[16:19], s42 offen
    buffer_load_dwordx4 v[44:47], v7, s[16:19], s42 offen
    v_mfma_f32_16x16x32_bf16 v[76:79], v[100:103], v[132:135], v[76:79]
    v_mfma_f32_16x16x32_bf16 v[92:95], v[104:107], v[132:135], v[92:95]
    s_waitcnt lgkmcnt(0)
    s_waitcnt vmcnt(16)
    s_barrier
    v_mfma_f32_16x16x32_bf16 v[48:51], v[108:111], v[136:139], v[48:51]
    ds_read_b128 v[96:99], v16 offset:40960
    v_mfma_f32_16x16x32_bf16 v[64:67], v[112:115], v[136:139], v[64:67]
    ds_read_b128 v[100:103], v16 offset:41984
    v_mfma_f32_16x16x32_bf16 v[80:83], v[116:119], v[136:139], v[80:83]
    ds_read_b128 v[104:107], v16 offset:43008
    v_mfma_f32_16x16x32_bf16 v[20:23], v[136:139], v[136:139], v[20:23]
    v_mfma_f32_16x16x32_bf16 v[52:55], v[108:111], v[140:143], v[52:55]
    ds_read_b64_tr_b16 v[120:121], v8 offset:40960
    ds_read_b64_tr_b16 v[122:123], v8 offset:41984
    v_mfma_f32_16x16x32_bf16 v[68:71], v[112:115], v[140:143], v[68:71]
    ds_read_b64_tr_b16 v[124:125], v9 offset:40960
    ds_read_b64_tr_b16 v[126:127], v9 offset:41984
    v_mfma_f32_16x16x32_bf16 v[84:87], v[116:119], v[140:143], v[84:87]
    ds_read_b64_tr_b16 v[128:129], v10 offset:40960
    ds_read_b64_tr_b16 v[130:131], v10 offset:41984
    v_mfma_f32_16x16x32_bf16 v[56:59], v[108:111], v[144:147], v[56:59]
    ds_read_b64_tr_b16 v[132:133], v11 offset:40960
    ds_read_b64_tr_b16 v[134:135], v11 offset:41984
    v_mfma_f32_16x16x32_bf16 v[72:75], v[112:115], v[144:147], v[72:75]
    s_mov_b32 m0, s69
    s_nop 0
    buffer_load_dwordx4 v1, s[60:63], s68 offen lds
    s_add_u32 s68, s68, 2048
    s_add_u32 s69, s69, 8192
    v_mfma_f32_16x16x32_bf16 v[88:91], v[116:119], v[144:147], v[88:91]
    s_mov_b32 m0, s69
    s_nop 0
    buffer_load_dwordx4 v1, s[60:63], s68 offen lds
    s_add_u32 s68, s68, 2048
    s_add_u32 s69, s69, 8192
    v_mfma_f32_16x16x32_bf16 v[60:63], v[108:111], v[148:151], v[60:63]
    s_mov_b32 m0, s69
    s_nop 0
    buffer_load_dwordx4 v1, s[60:63], s68 offen lds
    s_add_u32 s68, s68, 2048
    s_add_u32 s69, s69, 8192
    v_mfma_f32_16x16x32_bf16 v[76:79], v[112:115], v[148:151], v[76:79]
    v_mfma_f32_16x16x32_bf16 v[92:95], v[116:119], v[148:151], v[92:95]
    s_waitcnt lgkmcnt(6)
    v_mfma_f32_16x16x32_bf16 v[48:51], v[96:99], v[120:123], v[48:51]
    ds_read_b128 v[108:111], v16 offset:53248
    v_mfma_f32_16x16x32_bf16 v[64:67], v[100:103], v[120:123], v[64:67]
    ds_read_b128 v[112:115], v16 offset:54272
    v_mfma_f32_16x16x32_bf16 v[80:83], v[104:107], v[120:123], v[80:83]
    ds_read_b128 v[116:119], v16 offset:55296
    v_mfma_f32_16x16x32_bf16 v[20:23], v[120:123], v[120:123], v[20:23]
    s_waitcnt lgkmcnt(7)
    v_mfma_f32_16x16x32_bf16 v[52:55], v[96:99], v[124:127], v[52:55]
    ds_read_b64_tr_b16 v[136:137], v8 offset:49152
    ds_read_b64_tr_b16 v[138:139], v8 offset:50176
    v_mfma_f32_16x16x32_bf16 v[68:71], v[100:103], v[124:127], v[68:71]
    ds_read_b64_tr_b16 v[140:141], v9 offset:49152
    ds_read_b64_tr_b16 v[142:143], v9 offset:50176
    v_mfma_f32_16x16x32_bf16 v[84:87], v[104:107], v[124:127], v[84:87]
    ds_read_b64_tr_b16 v[144:145], v10 offset:49152
    ds_read_b64_tr_b16 v[146:147], v10 offset:50176
    s_waitcnt lgkmcnt(11)
    v_mfma_f32_16x16x32_bf16 v[56:59], v[96:99], v[128:131], v[56:59]
    ds_read_b64_tr_b16 v[148:149], v11 offset:49152
    ds_read_b64_tr_b16 v[150:151], v11 offset:50176
    v_mfma_f32_16x16x32_bf16 v[72:75], v[100:103], v[128:131], v[72:75]
    v_mfma_f32_16x16x32_bf16 v[88:91], v[104:107], v[128:131], v[88:91]
    s_waitcnt lgkmcnt(11)
    v_mfma_f32_16x16x32_bf16 v[60:63], v[96:99], v[132:135], v[60:63]
    v_mfma_f32_16x16x32_bf16 v[76:79], v[100:103], v[132:135], v[76:79]
    v_mfma_f32_16x16x32_bf16 v[92:95], v[104:107], v[132:135], v[92:95]
    s_waitcnt lgkmcnt(0)
    s_waitcnt vmcnt(14)
    s_barrier
    v_mfma_f32_16x16x32_bf16 v[48:51], v[108:111], v[136:139], v[48:51]
    ds_read_b128 v[96:99], v17 offset:0
    v_mfma_f32_16x16x32_bf16 v[64:67], v[112:115], v[136:139], v[64:67]
    ds_read_b128 v[100:103], v17 offset:1024
    v_mfma_f32_16x16x32_bf16 v[80:83], v[116:119], v[136:139], v[80:83]
    ds_read_b128 v[104:107], v17 offset:2048
    v_mfma_f32_16x16x32_bf16 v[20:23], v[136:139], v[136:139], v[20:23]
    v_mfma_f32_16x16x32_bf16 v[52:55], v[108:111], v[140:143], v[52:55]
    ds_read_b64_tr_b16 v[120:121], v12 offset:0
    ds_read_b64_tr_b16 v[122:123], v12 offset:1024
    v_mfma_f32_16x16x32_bf16 v[68:71], v[112:115], v[140:143], v[68:71]
    ds_read_b64_tr_b16 v[124:125], v13 offset:0
    ds_read_b64_tr_b16 v[126:127], v13 offset:1024
    v_mfma_f32_16x16x32_bf16 v[84:87], v[116:119], v[140:143], v[84:87]
    ds_read_b64_tr_b16 v[128:129], v14 offset:0
    ds_read_b64_tr_b16 v[130:131], v14 offset:1024
    v_mfma_f32_16x16x32_bf16 v[56:59], v[108:111], v[144:147], v[56:59]
    ds_read_b64_tr_b16 v[132:133], v15 offset:0
    ds_read_b64_tr_b16 v[134:135], v15 offset:1024
    v_mfma_f32_16x16x32_bf16 v[72:75], v[112:115], v[144:147], v[72:75]
    s_mov_b32 m0, s69
    s_nop 0
    buffer_load_dwordx4 v1, s[60:63], s68 offen lds
    s_add_u32 s68, s68, 2048
    s_add_u32 s69, s69, 8192
    v_mfma_f32_16x16x32_bf16 v[88:91], v[116:119], v[144:147], v[88:91]
    s_mov_b32 m0, s69
    s_nop 0
    buffer_load_dwordx4 v1, s[60:63], s68 offen lds
    s_add_u32 s68, s68, 2048
    s_add_u32 s69, s69, 8192
    v_mfma_f32_16x16x32_bf16 v[60:63], v[108:111], v[148:151], v[60:63]
    s_mov_b32 m0, s69
    s_nop 0
    buffer_load_dwordx4 v1, s[60:63], s68 offen lds
    s_add_u32 s68, s68, 2048
    s_add_u32 s69, s69, 8192
    v_mfma_f32_16x16x32_bf16 v[76:79], v[112:115], v[148:151], v[76:79]
    s_mov_b32 m0, s69
    s_nop 0
    buffer_load_dwordx4 v1, s[60:63], s68 offen lds
    s_add_u32 s68, s68, 2048
    s_add_u32 s69, s69, 8192
    v_mfma_f32_16x16x32_bf16 v[92:95], v[116:119], v[148:151], v[92:95]
    s_mov_b32 m0, s69
    s_nop 0
    buffer_load_dwordx4 v1, s[60:63], s68 offen lds
    s_add_u32 s68, s68, 2048
    s_add_u32 s69, s69, 8192
    s_waitcnt lgkmcnt(6)
    v_mfma_f32_16x16x32_bf16 v[48:51], v[96:99], v[120:123], v[48:51]
    ds_read_b128 v[108:111], v17 offset:12288
    v_mfma_f32_16x16x32_bf16 v[64:67], v[100:103], v[120:123], v[64:67]
    ds_read_b128 v[112:115], v17 offset:13312
    v_mfma_f32_16x16x32_bf16 v[80:83], v[104:107], v[120:123], v[80:83]
    ds_read_b128 v[116:119], v17 offset:14336
    v_mfma_f32_16x16x32_bf16 v[20:23], v[120:123], v[120:123], v[20:23]
    s_waitcnt lgkmcnt(7)
    v_mfma_f32_16x16x32_bf16 v[52:55], v[96:99], v[124:127], v[52:55]
    ds_read_b64_tr_b16 v[136:137], v12 offset:8192
    ds_read_b64_tr_b16 v[138:139], v12 offset:9216
    v_mfma_f32_16x16x32_bf16 v[68:71], v[100:103], v[124:127], v[68:71]
    ds_read_b64_tr_b16 v[140:141], v13 offset:8192
    ds_read_b64_tr_b16 v[142:143], v13 offset:9216
    v_mfma_f32_16x16x32_bf16 v[84:87], v[104:107], v[124:127], v[84:87]
    ds_read_b64_tr_b16 v[144:145], v14 offset:8192
    ds_read_b64_tr_b16 v[146:147], v14 offset:9216
    s_waitcnt lgkmcnt(11)
    v_mfma_f32_16x16x32_bf16 v[56:59], v[96:99], v[128:131], v[56:59]
    ds_read_b64_tr_b16 v[148:149], v15 offset:8192
    ds_read_b64_tr_b16 v[150:151], v15 offset:9216
    v_mfma_f32_16x16x32_bf16 v[72:75], v[100:103], v[128:131], v[72:75]
    v_mfma_f32_16x16x32_bf16 v[88:91], v[104:107], v[128:131], v[88:91]
    s_waitcnt lgkmcnt(11)
    v_mfma_f32_16x16x32_bf16 v[60:63], v[96:99], v[132:135], v[60:63]
    v_mfma_f32_16x16x32_bf16 v[76:79], v[100:103], v[132:135], v[76:79]
    v_mfma_f32_16x16x32_bf16 v[92:95], v[104:107], v[132:135], v[92:95]
    s_waitcnt lgkmcnt(0)
    s_waitcnt vmcnt(14)
    s_barrier
    v_mfma_f32_16x16x32_bf16 v[48:51], v[108:111], v[136:139], v[48:51]
    ds_read_b128 v[96:99], v17 offset:40960
    v_mfma_f32_16x16x32_bf16 v[64:67], v[112:115], v[136:139], v[64:67]
    ds_read_b128 v[100:103], v17 offset:41984
    v_mfma_f32_16x16x32_bf16 v[80:83], v[116:119], v[136:139], v[80:83]
    ds_read_b128 v[104:107], v17 offset:43008
    v_mfma_f32_16x16x32_bf16 v[20:23], v[136:139], v[136:139], v[20:23]
    v_mfma_f32_16x16x32_bf16 v[52:55], v[108:111], v[140:143], v[52:55]
    ds_read_b64_tr_b16 v[120:121], v12 offset:40960
    ds_read_b64_tr_b16 v[122:123], v12 offset:41984
    v_mfma_f32_16x16x32_bf16 v[68:71], v[112:115], v[140:143], v[68:71]
    ds_read_b64_tr_b16 v[124:125], v13 offset:40960
    ds_read_b64_tr_b16 v[126:127], v13 offset:41984
    v_mfma_f32_16x16x32_bf16 v[84:87], v[116:119], v[140:143], v[84:87]
    ds_read_b64_tr_b16 v[128:129], v14 offset:40960
    ds_read_b64_tr_b16 v[130:131], v14 offset:41984
    v_mfma_f32_16x16x32_bf16 v[56:59], v[108:111], v[144:147], v[56:59]
    ds_read_b64_tr_b16 v[132:133], v15 offset:40960
    ds_read_b64_tr_b16 v[134:135], v15 offset:41984
    v_mfma_f32_16x16x32_bf16 v[72:75], v[112:115], v[144:147], v[72:75]
    s_mov_b32 m0, s69
    s_nop 0
    buffer_load_dwordx4 v1, s[60:63], s68 offen lds
    s_add_u32 s68, s68, 2048
    s_add_u32 s69, s69, 8192
    v_mfma_f32_16x16x32_bf16 v[88:91], v[116:119], v[144:147], v[88:91]
    s_mov_b32 m0, s69
    s_nop 0
    buffer_load_dwordx4 v1, s[60:63], s68 offen lds
    s_add_u32 s68, s68, 2048
    s_add_u32 s69, s69, 8192
    v_mfma_f32_16x16x32_bf16 v[60:63], v[108:111], v[148:151], v[60:63]
    s_mov_b32 m0, s69
    s_nop 0
    buffer_load_dwordx4 v1, s[60:63], s68 offen lds
    s_add_u32 s68, s68, 2048
    s_add_u32 s69, s69, 8192
    v_mfma_f32_16x16x32_bf16 v[76:79], v[112:115], v[148:151], v[76:79]
    s_mov_b32 m0, s69
    s_nop 0
    buffer_load_dwordx4 v1, s[60:63], s68 offen lds
    s_add_u32 s68, s68, 2048
    s_add_u32 s69, s69, 8192
    v_mfma_f32_16x16x32_bf16 v[92:95], v[116:119], v[148:151], v[92:95]
    s_mov_b32 m0, s69
    s_nop 0
    buffer_load_dwordx4 v1, s[60:63], s68 offen lds
    s_add_u32 s68, s68, 2048
    s_add_u32 s69, s69, 8192
    s_waitcnt lgkmcnt(6)
    v_mfma_f32_16x16x32_bf16 v[48:51], v[96:99], v[120:123], v[48:51]
    ds_read_b128 v[108:111], v17 offset:53248
    v_mfma_f32_16x16x32_bf16 v[64:67], v[100:103], v[120:123], v[64:67]
    ds_read_b128 v[112:115], v17 offset:54272
    v_mfma_f32_16x16x32_bf16 v[80:83], v[104:107], v[120:123], v[80:83]
    ds_read_b128 v[116:119], v17 offset:55296
    v_mfma_f32_16x16x32_bf16 v[20:23], v[120:123], v[120:123], v[20:23]
    s_waitcnt lgkmcnt(7)
    v_mfma_f32_16x16x32_bf16 v[52:55], v[96:99], v[124:127], v[52:55]
    ds_read_b64_tr_b16 v[136:137], v12 offset:49152
    ds_read_b64_tr_b16 v[138:139], v12 offset:50176
    v_mfma_f32_16x16x32_bf16 v[68:71], v[100:103], v[124:127], v[68:71]
    ds_read_b64_tr_b16 v[140:141], v13 offset:49152
    ds_read_b64_tr_b16 v[142:143], v13 offset:50176
    v_mfma_f32_16x16x32_bf16 v[84:87], v[104:107], v[124:127], v[84:87]
    ds_read_b64_tr_b16 v[144:145], v14 offset:49152
    ds_read_b64_tr_b16 v[146:147], v14 offset:50176
    s_waitcnt lgkmcnt(11)
    v_mfma_f32_16x16x32_bf16 v[56:59], v[96:99], v[128:131], v[56:59]
    ds_read_b64_tr_b16 v[148:149], v15 offset:49152
    ds_read_b64_tr_b16 v[150:151], v15 offset:50176
    v_mfma_f32_16x16x32_bf16 v[72:75], v[100:103], v[128:131], v[72:75]
    v_mfma_f32_16x16x32_bf16 v[88:91], v[104:107], v[128:131], v[88:91]
    s_waitcnt lgkmcnt(11)
    v_mfma_f32_16x16x32_bf16 v[60:63], v[96:99], v[132:135], v[60:63]
    v_mfma_f32_16x16x32_bf16 v[76:79], v[100:103], v[132:135], v[76:79]
    v_mfma_f32_16x16x32_bf16 v[92:95], v[104:107], v[132:135], v[92:95]
    s_waitcnt lgkmcnt(6)
    v_mfma_f32_16x16x32_bf16 v[48:51], v[108:111], v[136:139], v[48:51]
    v_mfma_f32_16x16x32_bf16 v[64:67], v[112:115], v[136:139], v[64:67]
    v_mfma_f32_16x16x32_bf16 v[80:83], v[116:119], v[136:139], v[80:83]
    v_mfma_f32_16x16x32_bf16 v[20:23], v[136:139], v[136:139], v[20:23]
    s_waitcnt lgkmcnt(4)
    v_mfma_f32_16x16x32_bf16 v[52:55], v[108:111], v[140:143], v[52:55]
    v_mfma_f32_16x16x32_bf16 v[68:71], v[112:115], v[140:143], v[68:71]
    v_mfma_f32_16x16x32_bf16 v[84:87], v[116:119], v[140:143], v[84:87]
    s_waitcnt lgkmcnt(2)
    v_mfma_f32_16x16x32_bf16 v[56:59], v[108:111], v[144:147], v[56:59]
    v_mfma_f32_16x16x32_bf16 v[72:75], v[112:115], v[144:147], v[72:75]
    v_mfma_f32_16x16x32_bf16 v[88:91], v[116:119], v[144:147], v[88:91]
    s_waitcnt lgkmcnt(0)
    v_mfma_f32_16x16x32_bf16 v[60:63], v[108:111], v[148:151], v[60:63]
    v_mfma_f32_16x16x32_bf16 v[76:79], v[112:115], v[148:151], v[76:79]
    v_mfma_f32_16x16x32_bf16 v[92:95], v[116:119], v[148:151], v[92:95]
    s_add_u32 s30, s24, 0
    s_and_b32 s30, s30, 3
    s_add_u32 s30, s30, s49
    s_lshl_b32 s31, s30, 4
    v_add_u32 v96, s31, v5
    v_lshlrev_b32 v100, 2, v96
    s_add_u32 s30, s24, 1
    s_and_b32 s30, s30, 3
    s_add_u32 s30, s30, s49
    s_lshl_b32 s31, s30, 4
    v_add_u32 v97, s31, v5
    v_lshlrev_b32 v101, 2, v97
    s_add_u32 s30, s24, 2
    s_and_b32 s30, s30, 3
    s_add_u32 s30, s30, s49
    s_lshl_b32 s31, s30, 4
    v_add_u32 v98, s31, v5
    v_lshlrev_b32 v102, 2, v98
    s_add_u32 s30, s24, 3
    s_and_b32 s30, s30, 3
    s_add_u32 s30, s30, s49
    s_lshl_b32 s31, s30, 4
    v_add_u32 v99, s31, v5
    v_lshlrev_b32 v103, 2, v99
    v_and_b32 v7, 3, v5
    v_cmp_eq_u32 vcc, 1, v7
    s_nop 1
    v_cndmask_b32 v20, v20, v21, vcc
    v_cmp_eq_u32 vcc, 2, v7
    s_nop 1
    v_cndmask_b32 v20, v20, v22, vcc
    v_cmp_eq_u32 vcc, 3, v7
    s_nop 1
    v_cndmask_b32 v20, v20, v23, vcc
    v_lshrrev_b32 v7, 2, v5
    v_cmp_eq_u32 vcc, v7, v4
    s_nop 0
    s_and_saveexec_b64 s[30:31], vcc
    ds_write_b32 v100, v20 offset:512
    s_mov_b64 exec, s[30:31]
    s_cmp_lg_u32 s24, 3
    s_cbranch_scc1 ffn_nosum
    v_cmp_gt_u32 vcc, 16, v3
    s_nop 0
    s_and_saveexec_b64 s[30:31], vcc
    ds_write_b32 v100, v80
    ds_write_b32 v101, v84
    ds_write_b32 v102, v88
    ds_write_b32 v103, v92
    s_mov_b64 exec, s[30:31]
ffn_nosum:
    s_waitcnt lgkmcnt(0)
    s_barrier
    v_lshlrev_b32 v7, 3, v3
    ds_read_b64 v[128:129], v7
    ds_read_b64 v[130:131], v7 offset:512
    s_waitcnt vmcnt(13)
    s_mov_b32 m0, s69
    s_nop 0
    buffer_load_dwordx4 v1, s[60:63], s68 offen lds
    s_add_u32 s68, s68, 2048
    s_add_u32 s69, s69, 8192
    s_mov_b32 m0, s69
    s_nop 0
    buffer_load_dwordx4 v1, s[60:63], s68 offen lds
    s_add_u32 s68, s68, 2048
    s_add_u32 s69, s69, 8192
    s_mov_b32 m0, s69
    s_nop 0
    buffer_load_dwordx4 v1, s[60:63], s68 offen lds
    s_add_u32 s68, s68, 2048
    s_add_u32 s69, s69, 8192
    s_mov_b32 m0, s69
    s_nop 0
    buffer_load_dwordx4 v1, s[60:63], s68 offen lds
    s_add_u32 s68, s68, 2048
    s_add_u32 s69, s69, 8192
    s_mov_b32 m0, s69
    s_nop 0
    buffer_load_dwordx4 v1, s[60:63], s68 offen lds
    s_add_u32 s68, s68, 2048
    s_add_u32 s69, s69, 8192
    v_pk_add_f32 v[24:25], v[24:25], v[36:37]
    v_pk_add_f32 v[26:27], v[26:27], v[38:39]
    v_pk_add_f32 v[28:29], v[28:29], v[40:41]
    v_pk_add_f32 v[30:31], v[30:31], v[42:43]
    v_pk_add_f32 v[32:33], v[32:33], v[44:45]
    v_pk_add_f32 v[34:35], v[34:35], v[46:47]
    s_waitcnt lgkmcnt(0)
    v_mov_b32 v120, v128
    v_mov_b32 v121, v130
    v_mov_b32 v122, v129
    v_mov_b32 v123, v131
    v_mul_f32 v120, 0x3b000000, v120
    v_mul_f32 v121, 0x3b000000, v121
    v_fma_f32 v121, -v120, v120, v121
    v_max_f32 v121, 0, v121
    v_cvt_pk_bf16_f32 v132, v120, v121
    v_lshlrev_b32 v124, 16, v132
    v_and_b32 v126, 0xffff0000, v132
    v_add_f32 v126, 0x3727c5ac, v126
    v_mul_f32 v122, 0x3b000000, v122
    v_mul_f32 v123, 0x3b000000, v123
    v_fma_f32 v123, -v122, v122, v123
    v_max_f32 v123, 0, v123
    v_cvt_pk_bf16_f32 v132, v122, v123
    v_lshlrev_b32 v125, 16, v132
    v_and_b32 v127, 0xffff0000, v132
    v_add_f32 v127, 0x3727c5ac, v127
    v_cvt_pk_bf16_f32 v132, v126, v127
    v_lshlrev_b32 v126, 16, v132
    v_and_b32 v127, 0xffff0000, v132
    v_sqrt_f32 v126, v126
    v_sqrt_f32 v127, v127
    s_nop 0
    v_cvt_pk_bf16_f32 v132, v126, v127
    v_lshlrev_b32 v126, 16, v132
    v_and_b32 v127, 0xffff0000, v132
    v_rcp_f32 v126, v126
    v_rcp_f32 v127, v127
    v_mov_b32 v128, v126
    v_mul_f32 v129, v124, v126
    v_mov_b32 v130, v127
    v_mul_f32 v131, v125, v127
    s_lshl_b32 s30, s47, 10
    s_add_u32 s30, s30, 1024
    v_add_u32 v7, s30, v1
    ds_write_b128 v7, v[128:131]
    s_waitcnt lgkmcnt(0)
    v_lshl_add_u32 v7, v96, 3, s30
    ds_read_b64 v[8:9], v7
    v_lshl_add_u32 v7, v97, 3, s30
    ds_read_b64 v[10:11], v7
    v_lshl_add_u32 v7, v98, 3, s30
    ds_read_b64 v[12:13], v7
    v_lshl_add_u32 v7, v99, 3, s30
    ds_read_b64 v[14:15], v7
    v_add_u32 v6, s24, v4
    v_and_b32 v6, 3, v6
    v_add_u32 v6, s49, v6
    v_mul_u32_u24 v6, 45056, v6
    v_lshl_add_u32 v6, v5, 4, v6
    s_mov_b32 s30, 0xbfb8aa3b
    s_mov_b32 s31, 0xbfb8aa3b
    s_waitcnt lgkmcnt(0)
    v_pk_mul_f32 v[136:137], v[24:25], v[8:9] op_sel:[0,1] op_sel_hi:[1,1]
    v_pk_mul_f32 v[138:139], v[26:27], v[8:9] op_sel:[0,1] op_sel_hi:[1,1]
    v_pk_mul_f32 v[140:141], v[24:25], v[10:11] op_sel:[0,1] op_sel_hi:[1,1]
    v_pk_mul_f32 v[142:143], v[26:27], v[10:11] op_sel:[0,1] op_sel_hi:[1,1]
    v_pk_mul_f32 v[144:145], v[24:25], v[12:13] op_sel:[0,1] op_sel_hi:[1,1]
    v_pk_mul_f32 v[146:147], v[26:27], v[12:13] op_sel:[0,1] op_sel_hi:[1,1]
    v_pk_mul_f32 v[148:149], v[24:25], v[14:15] op_sel:[0,1] op_sel_hi:[1,1]
    v_pk_mul_f32 v[150:151], v[26:27], v[14:15] op_sel:[0,1] op_sel_hi:[1,1]
    v_pk_fma_f32 v[136:137], v[48:49], v[8:9], v[136:137] op_sel_hi:[1,0,1] neg_lo:[0,0,1] neg_hi:[0,0,1]
    v_pk_fma_f32 v[138:139], v[50:51], v[8:9], v[138:139] op_sel_hi:[1,0,1] neg_lo:[0,0,1] neg_hi:[0,0,1]
    v_pk_fma_f32 v[140:141], v[52:53], v[10:11], v[140:141] op_sel_hi:[1,0,1] neg_lo:[0,0,1] neg_hi:[0,0,1]
    v_pk_fma_f32 v[142:143], v[54:55], v[10:11], v[142:143] op_sel_hi:[1,0,1] neg_lo:[0,0,1] neg_hi:[0,0,1]
    v_pk_fma_f32 v[144:145], v[56:57], v[12:13], v[144:145] op_sel_hi:[1,0,1] neg_lo:[0,0,1] neg_hi:[0,0,1]
    v_pk_fma_f32 v[146:147], v[58:59], v[12:13], v[146:147] op_sel_hi:[1,0,1] neg_lo:[0,0,1] neg_hi:[0,0,1]
    v_pk_fma_f32 v[148:149], v[60:61], v[14:15], v[148:149] op_sel_hi:[1,0,1] neg_lo:[0,0,1] neg_hi:[0,0,1]
    v_pk_fma_f32 v[150:151], v[62:63], v[14:15], v[150:151] op_sel_hi:[1,0,1] neg_lo:[0,0,1] neg_hi:[0,0,1]
    v_pk_mul_f32 v[120:121], v[136:137], s[30:31]
    v_pk_mul_f32 v[122:123], v[140:141], s[30:31]
    v_pk_mul_f32 v[124:125], v[144:145], s[30:31]
    v_pk_mul_f32 v[126:127], v[148:149], s[30:31]
    v_exp_f32 v120, v120
    v_exp_f32 v121, v121
    v_exp_f32 v122, v122
    v_exp_f32 v123, v123
    v_exp_f32 v124, v124
    v_exp_f32 v125, v125
    v_exp_f32 v126, v126
    v_exp_f32 v127, v127
    v_pk_mul_f32 v[136:137], v[136:137], v[138:139]
    v_pk_mul_f32 v[140:141], v[140:141], v[142:143]
    v_pk_mul_f32 v[144:145], v[144:145], v[146:147]
    v_pk_mul_f32 v[148:149], v[148:149], v[150:151]
    v_pk_add_f32 v[120:121], v[120:121], 1.0 op_sel_hi:[1,0]
    v_pk_add_f32 v[122:123], v[122:123], 1.0 op_sel_hi:[1,0]
    v_pk_add_f32 v[124:125], v[124:125], 1.0 op_sel_hi:[1,0]
    v_pk_add_f32 v[126:127], v[126:127], 1.0 op_sel_hi:[1,0]
    v_rcp_f32 v120, v120
    v_rcp_f32 v121, v121
    v_rcp_f32 v122, v122
    v_rcp_f32 v123, v123
    v_rcp_f32 v124, v124
    v_rcp_f32 v125, v125
    v_rcp_f32 v126, v126
    v_rcp_f32 v127, v127
    v_pk_mul_f32 v[136:137], v[136:137], v[120:121]
    v_pk_mul_f32 v[140:141], v[140:141], v[122:123]
    v_pk_mul_f32 v[144:145], v[144:145], v[124:125]
    v_pk_mul_f32 v[148:149], v[148:149], v[126:127]
    v_cvt_pk_bf16_f32 v128, v136, v137
    v_cvt_pk_bf16_f32 v129, v140, v141
    v_cvt_pk_bf16_f32 v130, v144, v145
    v_cvt_pk_bf16_f32 v131, v148, v149
    s_nop 0
    v_permlane32_swap_b32 v128, v130
    v_permlane32_swap_b32 v129, v131
    s_nop 1
    v_permlane16_swap_b32 v128, v129
    v_permlane16_swap_b32 v130, v131
    buffer_store_dwordx4 v[128:131], v6, s[20:23], s36 offen sc1
    v_pk_mul_f32 v[136:137], v[28:29], v[8:9] op_sel:[0,1] op_sel_hi:[1,1]
    v_pk_mul_f32 v[138:139], v[30:31], v[8:9] op_sel:[0,1] op_sel_hi:[1,1]
    v_pk_mul_f32 v[140:141], v[28:29], v[10:11] op_sel:[0,1] op_sel_hi:[1,1]
    v_pk_mul_f32 v[142:143], v[30:31], v[10:11] op_sel:[0,1] op_sel_hi:[1,1]
    v_pk_mul_f32 v[144:145], v[28:29], v[12:13] op_sel:[0,1] op_sel_hi:[1,1]
    v_pk_mul_f32 v[146:147], v[30:31], v[12:13] op_sel:[0,1] op_sel_hi:[1,1]
    v_pk_mul_f32 v[148:149], v[28:29], v[14:15] op_sel:[0,1] op_sel_hi:[1,1]
    v_pk_mul_f32 v[150:151], v[30:31], v[14:15] op_sel:[0,1] op_sel_hi:[1,1]
    v_pk_fma_f32 v[136:137], v[64:65], v[8:9], v[136:137] op_sel_hi:[1,0,1] neg_lo:[0,0,1] neg_hi:[0,0,1]
    v_pk_fma_f32 v[138:139], v[66:67], v[8:9], v[138:139] op_sel_hi:[1,0,1] neg_lo:[0,0,1] neg_hi:[0,0,1]
    v_pk_fma_f32 v[140:141], v[68:69], v[10:11], v[140:141] op_sel_hi:[1,0,1] neg_lo:[0,0,1] neg_hi:[0,0,1]
    v_pk_fma_f32 v[142:143], v[70:71], v[10:11], v[142:143] op_sel_hi:[1,0,1] neg_lo:[0,0,1] neg_hi:[0,0,1]
    v_pk_fma_f32 v[144:145], v[72:73], v[12:13], v[144:145] op_sel_hi:[1,0,1] neg_lo:[0,0,1] neg_hi:[0,0,1]
    v_pk_fma_f32 v[146:147], v[74:75], v[12:13], v[146:147] op_sel_hi:[1,0,1] neg_lo:[0,0,1] neg_hi:[0,0,1]
    v_pk_fma_f32 v[148:149], v[76:77], v[14:15], v[148:149] op_sel_hi:[1,0,1] neg_lo:[0,0,1] neg_hi:[0,0,1]
    v_pk_fma_f32 v[150:151], v[78:79], v[14:15], v[150:151] op_sel_hi:[1,0,1] neg_lo:[0,0,1] neg_hi:[0,0,1]
    v_pk_mul_f32 v[120:121], v[136:137], s[30:31]
    v_pk_mul_f32 v[122:123], v[140:141], s[30:31]
    v_pk_mul_f32 v[124:125], v[144:145], s[30:31]
    v_pk_mul_f32 v[126:127], v[148:149], s[30:31]
    v_exp_f32 v120, v120
    v_exp_f32 v121, v121
    v_exp_f32 v122, v122
    v_exp_f32 v123, v123
    v_exp_f32 v124, v124
    v_exp_f32 v125, v125
    v_exp_f32 v126, v126
    v_exp_f32 v127, v127
    v_pk_mul_f32 v[136:137], v[136:137], v[138:139]
    v_pk_mul_f32 v[140:141], v[140:141], v[142:143]
    v_pk_mul_f32 v[144:145], v[144:145], v[146:147]
    v_pk_mul_f32 v[148:149], v[148:149], v[150:151]
    v_pk_add_f32 v[120:121], v[120:121], 1.0 op_sel_hi:[1,0]
    v_pk_add_f32 v[122:123], v[122:123], 1.0 op_sel_hi:[1,0]
    v_pk_add_f32 v[124:125], v[124:125], 1.0 op_sel_hi:[1,0]
    v_pk_add_f32 v[126:127], v[126:127], 1.0 op_sel_hi:[1,0]
    v_rcp_f32 v120, v120
    v_rcp_f32 v121, v121
    v_rcp_f32 v122, v122
    v_rcp_f32 v123, v123
    v_rcp_f32 v124, v124
    v_rcp_f32 v125, v125
    v_rcp_f32 v126, v126
    v_rcp_f32 v127, v127
    v_pk_mul_f32 v[136:137], v[136:137], v[120:121]
    v_pk_mul_f32 v[140:141], v[140:141], v[122:123]
    v_pk_mul_f32 v[144:145], v[144:145], v[124:125]
    v_pk_mul_f32 v[148:149], v[148:149], v[126:127]
    v_cvt_pk_bf16_f32 v132, v136, v137
    v_cvt_pk_bf16_f32 v133, v140, v141
    v_cvt_pk_bf16_f32 v134, v144, v145
    v_cvt_pk_bf16_f32 v135, v148, v149
    s_nop 0
    v_permlane32_swap_b32 v132, v134
    v_permlane32_swap_b32 v133, v135
    s_nop 1
    v_permlane16_swap_b32 v132, v133
    v_permlane16_swap_b32 v134, v135
    buffer_store_dwordx4 v[132:135], v6, s[20:23], s37 offen sc1
    v_pk_mul_f32 v[136:137], v[32:33], v[8:9] op_sel:[0,1] op_sel_hi:[1,1]
    v_pk_mul_f32 v[138:139], v[34:35], v[8:9] op_sel:[0,1] op_sel_hi:[1,1]
    v_pk_mul_f32 v[140:141], v[32:33], v[10:11] op_sel:[0,1] op_sel_hi:[1,1]
    v_pk_mul_f32 v[142:143], v[34:35], v[10:11] op_sel:[0,1] op_sel_hi:[1,1]
    v_pk_mul_f32 v[144:145], v[32:33], v[12:13] op_sel:[0,1] op_sel_hi:[1,1]
    v_pk_mul_f32 v[146:147], v[34:35], v[12:13] op_sel:[0,1] op_sel_hi:[1,1]
    v_pk_mul_f32 v[148:149], v[32:33], v[14:15] op_sel:[0,1] op_sel_hi:[1,1]
    v_pk_mul_f32 v[150:151], v[34:35], v[14:15] op_sel:[0,1] op_sel_hi:[1,1]
    v_pk_fma_f32 v[136:137], v[80:81], v[8:9], v[136:137] op_sel_hi:[1,0,1] neg_lo:[0,0,1] neg_hi:[0,0,1]
    v_pk_fma_f32 v[138:139], v[82:83], v[8:9], v[138:139] op_sel_hi:[1,0,1] neg_lo:[0,0,1] neg_hi:[0,0,1]
    v_pk_fma_f32 v[140:141], v[84:85], v[10:11], v[140:141] op_sel_hi:[1,0,1] neg_lo:[0,0,1] neg_hi:[0,0,1]
    v_pk_fma_f32 v[142:143], v[86:87], v[10:11], v[142:143] op_sel_hi:[1,0,1] neg_lo:[0,0,1] neg_hi:[0,0,1]
    v_pk_fma_f32 v[144:145], v[88:89], v[12:13], v[144:145] op_sel_hi:[1,0,1] neg_lo:[0,0,1] neg_hi:[0,0,1]
    v_pk_fma_f32 v[146:147], v[90:91], v[12:13], v[146:147] op_sel_hi:[1,0,1] neg_lo:[0,0,1] neg_hi:[0,0,1]
    v_pk_fma_f32 v[148:149], v[92:93], v[14:15], v[148:149] op_sel_hi:[1,0,1] neg_lo:[0,0,1] neg_hi:[0,0,1]
    v_pk_fma_f32 v[150:151], v[94:95], v[14:15], v[150:151] op_sel_hi:[1,0,1] neg_lo:[0,0,1] neg_hi:[0,0,1]
    v_pk_mul_f32 v[120:121], v[136:137], s[30:31]
    v_pk_mul_f32 v[122:123], v[140:141], s[30:31]
    v_pk_mul_f32 v[124:125], v[144:145], s[30:31]
    v_pk_mul_f32 v[126:127], v[148:149], s[30:31]
    v_exp_f32 v120, v120
    v_exp_f32 v121, v121
    v_exp_f32 v122, v122
    v_exp_f32 v123, v123
    v_exp_f32 v124, v124
    v_exp_f32 v125, v125
    v_exp_f32 v126, v126
    v_exp_f32 v127, v127
    v_pk_mul_f32 v[136:137], v[136:137], v[138:139]
    v_pk_mul_f32 v[140:141], v[140:141], v[142:143]
    v_pk_mul_f32 v[144:145], v[144:145], v[146:147]
    v_pk_mul_f32 v[148:149], v[148:149], v[150:151]
    v_pk_add_f32 v[120:121], v[120:121], 1.0 op_sel_hi:[1,0]
    v_pk_add_f32 v[122:123], v[122:123], 1.0 op_sel_hi:[1,0]
    v_pk_add_f32 v[124:125], v[124:125], 1.0 op_sel_hi:[1,0]
    v_pk_add_f32 v[126:127], v[126:127], 1.0 op_sel_hi:[1,0]
    v_rcp_f32 v120, v120
    v_rcp_f32 v121, v121
    v_rcp_f32 v122, v122
    v_rcp_f32 v123, v123
    v_rcp_f32 v124, v124
    v_rcp_f32 v125, v125
    v_rcp_f32 v126, v126
    v_rcp_f32 v127, v127
    v_pk_mul_f32 v[136:137], v[136:137], v[120:121]
    v_pk_mul_f32 v[140:141], v[140:141], v[122:123]
    v_pk_mul_f32 v[144:145], v[144:145], v[124:125]
    v_pk_mul_f32 v[148:149], v[148:149], v[126:127]
    v_cvt_pk_bf16_f32 v128, v136, v137
    v_cvt_pk_bf16_f32 v129, v140, v141
    v_cvt_pk_bf16_f32 v130, v144, v145
    v_cvt_pk_bf16_f32 v131, v148, v149
    s_nop 0
    v_permlane32_swap_b32 v128, v130
    v_permlane32_swap_b32 v129, v131
    s_nop 1
    v_permlane16_swap_b32 v128, v129
    v_permlane16_swap_b32 v130, v131
    buffer_store_dwordx4 v[128:131], v6, s[20:23], s38 offen sc1
    s_and_b32 s30, s28, 1
    s_lshl_b32 s29, s27, 1
    s_add_u32 s29, s29, s30
    s_lshl_b32 s30, s29, 2
    s_lshl_b32 s31, s46, 1
    s_add_u32 s30, s30, s31
    s_add_u32 s30, s30, 0
    s_mul_i32 s36, s30, 45056
    s_lshl_b32 s30, s29, 2
    s_lshl_b32 s31, s46, 1
    s_add_u32 s30, s30, s31
    s_add_u32 s30, s30, 1
    s_mul_i32 s37, s30, 45056
    s_lshl_b32 s31, s24, 10
    v_add_u32 v8, s31, v1
    s_lshl_b32 s31, s24, 12
    s_add_u32 s31, s31, 10240
    v_add_u32 v9, s31, v1
    v_and_b32 v10, 7, v0
    v_lshrrev_b32 v11, 3, v0
    v_lshlrev_b32 v12, 8, v11
    v_lshl_add_u32 v12, v10, 4, v12
    s_lshl_b32 s31, s26, 14
    s_lshl_b32 s40, s27, 17
    s_add_u32 s31, s31, s40
    s_and_b32 s40, s28, 1
    s_lshl_b32 s40, s40, 7
    s_add_u32 s31, s31, s40
    v_add_u32 v12, s31, v12
    buffer_load_dwordx4 v[16:19], v12, s[8:11], 0 offen
    s_add_u32 s12, s4, 0x900000
    s_addc_u32 s13, s5, 0
    s_mov_b32 s14, 0x200000
    s_mov_b32 s15, 0x00020000
    s_add_u32 s16, s4, 0xd10000
    s_addc_u32 s17, s5, 0
    s_mov_b32 s18, 0x4000
    s_mov_b32 s19, 0x00020000
    s_mov_b32 s32, s6
    s_mov_b32 s33, s7
    s_mov_b32 s34, 0x200000
    s_mov_b32 s35, 0x00020000
    s_waitcnt vmcnt(0)
    s_barrier
    s_lshl_b32 s30, s51, 4
    s_add_u32 s30, s30, s27
    s_lshl_b32 s30, s30, 7
    v_mov_b32 v6, 0
    v_mov_b32 v7, 1
    v_cmp_eq_u32 vcc, 0, v0
    s_nop 0
    s_and_saveexec_b64 s[40:41], vcc
    s_lshl_b32 s30, s30, 4
    s_lshl_b32 s31, s28, 7
    s_add_u32 s31, s31, s30
    buffer_store_dword v7, v6, s[64:67], s31 offen sc1
    s_mov_b64 exec, s[40:41]
    s_mov_b32 s43, s30
    v_lshlrev_b32 v6, 7, v3
    v_cmp_gt_u32 vcc, 16, v0
    s_lshl_b32 s30, s26, 2
    s_add_u32 s30, s30, 0
    s_mul_i32 s30, s30, 44032
    s_lshl_b32 s31, s24, 10
    s_add_u32 s30, s30, s31
    s_add_u32 s30, s30, 36864
    buffer_load_dwordx4 a[0:3], v1, s[60:63], s30 offen
    s_lshl_b32 s30, s26, 2
    s_add_u32 s30, s30, 1
    s_mul_i32 s30, s30, 44032
    s_lshl_b32 s31, s24, 10
    s_add_u32 s30, s30, s31
    s_add_u32 s30, s30, 36864
    buffer_load_dwordx4 a[4:7], v1, s[60:63], s30 offen
    s_lshl_b32 s30, s26, 2
    s_add_u32 s30, s30, 2
    s_mul_i32 s30, s30, 44032
    s_lshl_b32 s31, s24, 10
    s_add_u32 s30, s30, s31
    s_add_u32 s30, s30, 36864
    buffer_load_dwordx4 a[8:11], v1, s[60:63], s30 offen
    s_lshl_b32 s30, s26, 2
    s_add_u32 s30, s30, 3
    s_mul_i32 s30, s30, 44032
    s_lshl_b32 s31, s24, 10
    s_add_u32 s30, s30, s31
    s_add_u32 s30, s30, 36864
    buffer_load_dwordx4 a[12:15], v1, s[60:63], s30 offen
    s_lshl_b32 s30, s26, 2
    s_add_u32 s30, s30, 0
    s_mul_i32 s30, s30, 44032
    s_lshl_b32 s31, s24, 10
    s_add_u32 s30, s30, s31
    s_add_u32 s30, s30, 40960
    buffer_load_dwordx4 a[16:19], v1, s[60:63], s30 offen
    s_lshl_b32 s30, s26, 2
    s_add_u32 s30, s30, 1
    s_mul_i32 s30, s30, 44032
    s_lshl_b32 s31, s24, 10
    s_add_u32 s30, s30, s31
    s_add_u32 s30, s30, 40960
    buffer_load_dwordx4 a[20:23], v1, s[60:63], s30 offen
    s_lshl_b32 s30, s26, 2
    s_add_u32 s30, s30, 2
    s_mul_i32 s30, s30, 44032
    s_lshl_b32 s31, s24, 10
    s_add_u32 s30, s30, s31
    s_add_u32 s30, s30, 40960
    buffer_load_dwordx4 a[24:27], v1, s[60:63], s30 offen
    s_lshl_b32 s30, s26, 2
    s_add_u32 s30, s30, 3
    s_mul_i32 s30, s30, 44032
    s_lshl_b32 s31, s24, 10
    s_add_u32 s30, s30, s31
    s_add_u32 s30, s30, 40960
    buffer_load_dwordx4 a[28:31], v1, s[60:63], s30 offen
    s_cmp_lg_u32 s47, 0
    s_cbranch_scc1 ffn_wait
    s_and_saveexec_b64 s[40:41], vcc
    s_mov_b32 s31, 0
ffn_poll:
    buffer_load_dword v7, v6, s[64:67], s43 offen sc1
    s_waitcnt vmcnt(0)
    v_cmp_ne_u32 vcc, 0, v7
    s_nop 0
    s_cmp_eq_u32 vcc_lo, 0xffff
    s_cbranch_scc1 ffn_ready
    s_add_u32 s31, s31, 1
    s_cmp_ge_u32 s31, 0x40000
    s_cbranch_scc1 ffn_ready
    s_sleep 2
    s_branch ffn_poll
ffn_ready:
    s_mov_b64 exec, s[40:41]
ffn_wait:
    s_nop 3
    s_barrier
    buffer_load_dwordx4 v[64:67], v8, s[20:23], s36 offen sc1
    buffer_load_dwordx4 v[68:71], v8, s[20:23], s37 offen sc1
    v_add_u32 v8, 0x1000, v8
    buffer_load_dwordx4 v[72:75], v8, s[20:23], s36 offen sc1
    buffer_load_dwordx4 v[76:79], v8, s[20:23], s37 offen sc1
    v_add_u32 v8, 0x1000, v8
    buffer_load_dwordx4 v[80:83], v8, s[20:23], s36 offen sc1
    buffer_load_dwordx4 v[84:87], v8, s[20:23], s37 offen sc1
    v_add_u32 v8, 0x1000, v8
    buffer_load_dwordx4 v[88:91], v8, s[20:23], s36 offen sc1
    buffer_load_dwordx4 v[92:95], v8, s[20:23], s37 offen sc1
    ds_read_b128 a[32:35], v9 offset:0
    ds_read_b128 a[36:39], v9 offset:1024
    ds_read_b128 a[40:43], v9 offset:2048
    ds_read_b128 a[44:47], v9 offset:3072
    ds_read_b128 a[48:51], v9 offset:16384
    ds_read_b128 a[52:55], v9 offset:17408
    ds_read_b128 a[56:59], v9 offset:18432
    ds_read_b128 a[60:63], v9 offset:19456
    v_add_u32 v8, 0x1000, v8
    buffer_load_dwordx4 v[96:99], v8, s[20:23], s36 offen sc1
    buffer_load_dwordx4 v[100:103], v8, s[20:23], s37 offen sc1
    s_waitcnt vmcnt(8)
    s_waitcnt lgkmcnt(4)
    v_mfma_f32_16x16x32_bf16 v[32:35], v[64:67], a[32:35], 0
    v_mfma_f32_16x16x32_bf16 v[36:39], v[64:67], a[36:39], 0
    v_mfma_f32_16x16x32_bf16 v[40:43], v[64:67], a[40:43], 0
    v_mfma_f32_16x16x32_bf16 v[44:47], v[64:67], a[44:47], 0
    v_mfma_f32_16x16x32_bf16 v[48:51], v[68:71], a[32:35], 0
    v_mfma_f32_16x16x32_bf16 v[52:55], v[68:71], a[36:39], 0
    v_mfma_f32_16x16x32_bf16 v[56:59], v[68:71], a[40:43], 0
    v_mfma_f32_16x16x32_bf16 v[60:63], v[68:71], a[44:47], 0
    ds_read_b128 a[32:35], v9 offset:32768
    ds_read_b128 a[36:39], v9 offset:33792
    ds_read_b128 a[40:43], v9 offset:34816
    ds_read_b128 a[44:47], v9 offset:35840
    v_add_u32 v8, 0x1000, v8
    buffer_load_dwordx4 v[104:107], v8, s[20:23], s36 offen sc1
    buffer_load_dwordx4 v[108:111], v8, s[20:23], s37 offen sc1
    s_waitcnt vmcnt(8)
    s_waitcnt lgkmcnt(4)
    v_mfma_f32_16x16x32_bf16 v[32:35], v[72:75], a[48:51], v[32:35]
    v_mfma_f32_16x16x32_bf16 v[36:39], v[72:75], a[52:55], v[36:39]
    v_mfma_f32_16x16x32_bf16 v[40:43], v[72:75], a[56:59], v[40:43]
    v_mfma_f32_16x16x32_bf16 v[44:47], v[72:75], a[60:63], v[44:47]
    v_mfma_f32_16x16x32_bf16 v[48:51], v[76:79], a[48:51], v[48:51]
    v_mfma_f32_16x16x32_bf16 v[52:55], v[76:79], a[52:55], v[52:55]
    v_mfma_f32_16x16x32_bf16 v[56:59], v[76:79], a[56:59], v[56:59]
    v_mfma_f32_16x16x32_bf16 v[60:63], v[76:79], a[60:63], v[60:63]
    ds_read_b128 a[48:51], v9 offset:49152
    ds_read_b128 a[52:55], v9 offset:50176
    ds_read_b128 a[56:59], v9 offset:51200
    ds_read_b128 a[60:63], v9 offset:52224
    v_add_u32 v8, 0x1000, v8
    buffer_load_dwordx4 v[112:115], v8, s[20:23], s36 offen sc1
    buffer_load_dwordx4 v[116:119], v8, s[20:23], s37 offen sc1
    s_waitcnt vmcnt(8)
    s_waitcnt lgkmcnt(4)
    v_mfma_f32_16x16x32_bf16 v[32:35], v[80:83], a[32:35], v[32:35]
    v_mfma_f32_16x16x32_bf16 v[36:39], v[80:83], a[36:39], v[36:39]
    v_mfma_f32_16x16x32_bf16 v[40:43], v[80:83], a[40:43], v[40:43]
    v_mfma_f32_16x16x32_bf16 v[44:47], v[80:83], a[44:47], v[44:47]
    v_mfma_f32_16x16x32_bf16 v[48:51], v[84:87], a[32:35], v[48:51]
    v_mfma_f32_16x16x32_bf16 v[52:55], v[84:87], a[36:39], v[52:55]
    v_mfma_f32_16x16x32_bf16 v[56:59], v[84:87], a[40:43], v[56:59]
    v_mfma_f32_16x16x32_bf16 v[60:63], v[84:87], a[44:47], v[60:63]
    v_add_u32 v9, 0x10000, v9
    ds_read_b128 a[32:35], v9 offset:0
    ds_read_b128 a[36:39], v9 offset:1024
    ds_read_b128 a[40:43], v9 offset:2048
    ds_read_b128 a[44:47], v9 offset:3072
    v_add_u32 v8, 0x1000, v8
    buffer_load_dwordx4 v[120:123], v8, s[20:23], s36 offen sc1
    buffer_load_dwordx4 v[124:127], v8, s[20:23], s37 offen sc1
    s_waitcnt vmcnt(8)
    s_waitcnt lgkmcnt(4)
    v_mfma_f32_16x16x32_bf16 v[32:35], v[88:91], a[48:51], v[32:35]
    v_mfma_f32_16x16x32_bf16 v[36:39], v[88:91], a[52:55], v[36:39]
    v_mfma_f32_16x16x32_bf16 v[40:43], v[88:91], a[56:59], v[40:43]
    v_mfma_f32_16x16x32_bf16 v[44:47], v[88:91], a[60:63], v[44:47]
    v_mfma_f32_16x16x32_bf16 v[48:51], v[92:95], a[48:51], v[48:51]
    v_mfma_f32_16x16x32_bf16 v[52:55], v[92:95], a[52:55], v[52:55]
    v_mfma_f32_16x16x32_bf16 v[56:59], v[92:95], a[56:59], v[56:59]
    v_mfma_f32_16x16x32_bf16 v[60:63], v[92:95], a[60:63], v[60:63]
    ds_read_b128 a[48:51], v9 offset:16384
    ds_read_b128 a[52:55], v9 offset:17408
    ds_read_b128 a[56:59], v9 offset:18432
    ds_read_b128 a[60:63], v9 offset:19456
    v_add_u32 v8, 0x1000, v8
    buffer_load_dwordx4 v[128:131], v8, s[20:23], s36 offen sc1
    buffer_load_dwordx4 v[132:135], v8, s[20:23], s37 offen sc1
    s_waitcnt vmcnt(8)
    s_waitcnt lgkmcnt(4)
    v_mfma_f32_16x16x32_bf16 v[32:35], v[96:99], a[32:35], v[32:35]
    v_mfma_f32_16x16x32_bf16 v[36:39], v[96:99], a[36:39], v[36:39]
    v_mfma_f32_16x16x32_bf16 v[40:43], v[96:99], a[40:43], v[40:43]
    v_mfma_f32_16x16x32_bf16 v[44:47], v[96:99], a[44:47], v[44:47]
    v_mfma_f32_16x16x32_bf16 v[48:51], v[100:103], a[32:35], v[48:51]
    v_mfma_f32_16x16x32_bf16 v[52:55], v[100:103], a[36:39], v[52:55]
    v_mfma_f32_16x16x32_bf16 v[56:59], v[100:103], a[40:43], v[56:59]
    v_mfma_f32_16x16x32_bf16 v[60:63], v[100:103], a[44:47], v[60:63]
    ds_read_b128 a[32:35], v9 offset:32768
    ds_read_b128 a[36:39], v9 offset:33792
    ds_read_b128 a[40:43], v9 offset:34816
    ds_read_b128 a[44:47], v9 offset:35840
    v_add_u32 v8, 0x1000, v8
    buffer_load_dwordx4 v[136:139], v8, s[20:23], s36 offen sc1
    buffer_load_dwordx4 v[140:143], v8, s[20:23], s37 offen sc1
    s_waitcnt vmcnt(8)
    s_waitcnt lgkmcnt(4)
    v_mfma_f32_16x16x32_bf16 v[32:35], v[104:107], a[48:51], v[32:35]
    v_mfma_f32_16x16x32_bf16 v[36:39], v[104:107], a[52:55], v[36:39]
    v_mfma_f32_16x16x32_bf16 v[40:43], v[104:107], a[56:59], v[40:43]
    v_mfma_f32_16x16x32_bf16 v[44:47], v[104:107], a[60:63], v[44:47]
    v_mfma_f32_16x16x32_bf16 v[48:51], v[108:111], a[48:51], v[48:51]
    v_mfma_f32_16x16x32_bf16 v[52:55], v[108:111], a[52:55], v[52:55]
    v_mfma_f32_16x16x32_bf16 v[56:59], v[108:111], a[56:59], v[56:59]
    v_mfma_f32_16x16x32_bf16 v[60:63], v[108:111], a[60:63], v[60:63]
    ds_read_b128 a[48:51], v9 offset:49152
    ds_read_b128 a[52:55], v9 offset:50176
    ds_read_b128 a[56:59], v9 offset:51200
    ds_read_b128 a[60:63], v9 offset:52224
    v_add_u32 v8, 0x1000, v8
    buffer_load_dwordx4 v[144:147], v8, s[20:23], s36 offen sc1
    buffer_load_dwordx4 v[148:151], v8, s[20:23], s37 offen sc1
    s_waitcnt vmcnt(8)
    s_waitcnt lgkmcnt(4)
    v_mfma_f32_16x16x32_bf16 v[32:35], v[112:115], a[32:35], v[32:35]
    v_mfma_f32_16x16x32_bf16 v[36:39], v[112:115], a[36:39], v[36:39]
    v_mfma_f32_16x16x32_bf16 v[40:43], v[112:115], a[40:43], v[40:43]
    v_mfma_f32_16x16x32_bf16 v[44:47], v[112:115], a[44:47], v[44:47]
    v_mfma_f32_16x16x32_bf16 v[48:51], v[116:119], a[32:35], v[48:51]
    v_mfma_f32_16x16x32_bf16 v[52:55], v[116:119], a[36:39], v[52:55]
    v_mfma_f32_16x16x32_bf16 v[56:59], v[116:119], a[40:43], v[56:59]
    v_mfma_f32_16x16x32_bf16 v[60:63], v[116:119], a[44:47], v[60:63]
    v_add_u32 v9, 0x10000, v9
    ds_read_b128 a[32:35], v9 offset:0
    ds_read_b128 a[36:39], v9 offset:1024
    ds_read_b128 a[40:43], v9 offset:2048
    ds_read_b128 a[44:47], v9 offset:3072
    s_waitcnt vmcnt(6)
    s_waitcnt lgkmcnt(4)
    v_mfma_f32_16x16x32_bf16 v[32:35], v[120:123], a[48:51], v[32:35]
    v_mfma_f32_16x16x32_bf16 v[36:39], v[120:123], a[52:55], v[36:39]
    v_mfma_f32_16x16x32_bf16 v[40:43], v[120:123], a[56:59], v[40:43]
    v_mfma_f32_16x16x32_bf16 v[44:47], v[120:123], a[60:63], v[44:47]
    v_mfma_f32_16x16x32_bf16 v[48:51], v[124:127], a[48:51], v[48:51]
    v_mfma_f32_16x16x32_bf16 v[52:55], v[124:127], a[52:55], v[52:55]
    v_mfma_f32_16x16x32_bf16 v[56:59], v[124:127], a[56:59], v[56:59]
    v_mfma_f32_16x16x32_bf16 v[60:63], v[124:127], a[60:63], v[60:63]
    s_waitcnt vmcnt(4)
    s_waitcnt lgkmcnt(0)
    s_barrier
    v_mfma_f32_16x16x32_bf16 v[32:35], v[128:131], a[32:35], v[32:35]
    v_mfma_f32_16x16x32_bf16 v[36:39], v[128:131], a[36:39], v[36:39]
    v_mfma_f32_16x16x32_bf16 v[40:43], v[128:131], a[40:43], v[40:43]
    v_mfma_f32_16x16x32_bf16 v[44:47], v[128:131], a[44:47], v[44:47]
    v_mfma_f32_16x16x32_bf16 v[48:51], v[132:135], a[32:35], v[48:51]
    v_mfma_f32_16x16x32_bf16 v[52:55], v[132:135], a[36:39], v[52:55]
    v_mfma_f32_16x16x32_bf16 v[56:59], v[132:135], a[40:43], v[56:59]
    v_mfma_f32_16x16x32_bf16 v[60:63], v[132:135], a[44:47], v[60:63]
    s_waitcnt vmcnt(2)
    v_mfma_f32_16x16x32_bf16 v[32:35], v[136:139], a[0:3], v[32:35]
    v_mfma_f32_16x16x32_bf16 v[36:39], v[136:139], a[4:7], v[36:39]
    v_mfma_f32_16x16x32_bf16 v[40:43], v[136:139], a[8:11], v[40:43]
    v_mfma_f32_16x16x32_bf16 v[44:47], v[136:139], a[12:15], v[44:47]
    v_mfma_f32_16x16x32_bf16 v[48:51], v[140:143], a[0:3], v[48:51]
    v_mfma_f32_16x16x32_bf16 v[52:55], v[140:143], a[4:7], v[52:55]
    v_mfma_f32_16x16x32_bf16 v[56:59], v[140:143], a[8:11], v[56:59]
    v_mfma_f32_16x16x32_bf16 v[60:63], v[140:143], a[12:15], v[60:63]
    s_waitcnt vmcnt(0)
    v_mfma_f32_16x16x32_bf16 v[32:35], v[144:147], a[16:19], v[32:35]
    v_mfma_f32_16x16x32_bf16 v[36:39], v[144:147], a[20:23], v[36:39]
    v_mfma_f32_16x16x32_bf16 v[40:43], v[144:147], a[24:27], v[40:43]
    v_mfma_f32_16x16x32_bf16 v[44:47], v[144:147], a[28:31], v[44:47]
    v_mfma_f32_16x16x32_bf16 v[48:51], v[148:151], a[16:19], v[48:51]
    v_mfma_f32_16x16x32_bf16 v[52:55], v[148:151], a[20:23], v[52:55]
    v_mfma_f32_16x16x32_bf16 v[56:59], v[148:151], a[24:27], v[56:59]
    v_mfma_f32_16x16x32_bf16 v[60:63], v[148:151], a[28:31], v[60:63]
    v_mul_u32_u24 v6, 272, v5
    v_lshl_add_u32 v6, v4, 4, v6
    s_mul_i32 s31, s24, 17408
    s_lshl_b32 s30, s46, 7
    s_add_u32 s31, s31, s30
    v_add_u32 v6, s31, v6
    ds_write_b128 v6, v[32:35] offset:0
    ds_write_b128 v6, v[36:39] offset:4352
    ds_write_b128 v6, v[40:43] offset:8704
    ds_write_b128 v6, v[44:47] offset:13056
    ds_write_b128 v6, v[48:51] offset:64
    ds_write_b128 v6, v[52:55] offset:4416
    ds_write_b128 v6, v[56:59] offset:8768
    ds_write_b128 v6, v[60:63] offset:13120
    s_waitcnt lgkmcnt(0)
    s_barrier
    v_mul_u32_u24 v6, 272, v11
    v_lshl_add_u32 v6, v10, 5, v6
    ds_read_b128 v[64:67], v6 offset:0
    ds_read_b128 v[68:71], v6 offset:16
    ds_read_b128 v[72:75], v6 offset:17408
    ds_read_b128 v[76:79], v6 offset:17424
    ds_read_b128 v[80:83], v6 offset:34816
    ds_read_b128 v[84:87], v6 offset:34832
    ds_read_b128 v[88:91], v6 offset:52224
    ds_read_b128 v[92:95], v6 offset:52240
    v_lshlrev_b32 v44, 16, v16
    v_and_b32 v45, 0xffff0000, v16
    v_lshlrev_b32 v46, 16, v17
    v_and_b32 v47, 0xffff0000, v17
    v_lshlrev_b32 v48, 16, v18
    v_and_b32 v49, 0xffff0000, v18
    v_lshlrev_b32 v50, 16, v19
    v_and_b32 v51, 0xffff0000, v19
    s_waitcnt lgkmcnt(0)
    v_pk_add_f32 v[64:65], v[64:65], v[72:73]
    v_pk_add_f32 v[80:81], v[80:81], v[88:89]
    v_pk_add_f32 v[32:33], v[64:65], v[80:81]
    v_pk_add_f32 v[66:67], v[66:67], v[74:75]
    v_pk_add_f32 v[82:83], v[82:83], v[90:91]
    v_pk_add_f32 v[34:35], v[66:67], v[82:83]
    v_pk_add_f32 v[68:69], v[68:69], v[76:77]
    v_pk_add_f32 v[84:85], v[84:85], v[92:93]
    v_pk_add_f32 v[36:37], v[68:69], v[84:85]
    v_pk_add_f32 v[70:71], v[70:71], v[78:79]
    v_pk_add_f32 v[86:87], v[86:87], v[94:95]
    v_pk_add_f32 v[38:39], v[70:71], v[86:87]
    v_cvt_pk_bf16_f32 v52, v32, v33
    v_lshlrev_b32 v32, 16, v52
    v_and_b32 v33, 0xffff0000, v52
    v_cvt_pk_bf16_f32 v52, v34, v35
    v_lshlrev_b32 v34, 16, v52
    v_and_b32 v35, 0xffff0000, v52
    v_cvt_pk_bf16_f32 v52, v36, v37
    v_lshlrev_b32 v36, 16, v52
    v_and_b32 v37, 0xffff0000, v52
    v_cvt_pk_bf16_f32 v52, v38, v39
    v_lshlrev_b32 v38, 16, v52
    v_and_b32 v39, 0xffff0000, v52
    v_pk_add_f32 v[32:33], v[32:33], v[44:45]
    v_pk_add_f32 v[34:35], v[34:35], v[46:47]
    v_pk_add_f32 v[36:37], v[36:37], v[48:49]
    v_pk_add_f32 v[38:39], v[38:39], v[50:51]
    v_cvt_pk_bf16_f32 v40, v32, v33
    v_cvt_pk_bf16_f32 v41, v34, v35
    v_cvt_pk_bf16_f32 v42, v36, v37
    v_cvt_pk_bf16_f32 v43, v38, v39
    s_cmp_lg_u32 s51, 0
    s_cbranch_scc1 ffn_final
    buffer_store_dwordx4 v[40:43], v12, s[12:15], 0 offen sc1
    v_lshlrev_b32 v64, 16, v40
    v_and_b32 v65, 0xffff0000, v40
    v_lshlrev_b32 v66, 16, v41
    v_and_b32 v67, 0xffff0000, v41
    v_lshlrev_b32 v68, 16, v42
    v_and_b32 v69, 0xffff0000, v42
    v_lshlrev_b32 v70, 16, v43
    v_and_b32 v71, 0xffff0000, v43
    v_pk_mul_f32 v[72:73], v[64:65], v[64:65]
    v_pk_mul_f32 v[74:75], v[66:67], v[66:67]
    v_pk_mul_f32 v[76:77], v[68:69], v[68:69]
    v_pk_mul_f32 v[78:79], v[70:71], v[70:71]
    v_permlane32_swap_b32 v64, v68
    v_permlane32_swap_b32 v65, v69
    v_permlane32_swap_b32 v66, v70
    v_permlane32_swap_b32 v67, v71
    v_pk_add_f32 v[64:65], v[64:65], v[68:69]
    v_pk_add_f32 v[66:67], v[66:67], v[70:71]
    v_permlane32_swap_b32 v72, v76
    v_permlane32_swap_b32 v73, v77
    v_permlane32_swap_b32 v74, v78
    v_permlane32_swap_b32 v75, v79
    v_pk_add_f32 v[72:73], v[72:73], v[76:77]
    v_pk_add_f32 v[74:75], v[74:75], v[78:79]
    v_permlane16_swap_b32 v64, v66
    v_permlane16_swap_b32 v65, v67
    v_pk_add_f32 v[64:65], v[64:65], v[66:67]
    v_permlane16_swap_b32 v72, v74
    v_permlane16_swap_b32 v73, v75
    v_pk_add_f32 v[72:73], v[72:73], v[74:75]
    v_add_f32_dpp v68, v64, v64 row_ror:8 row_mask:0xf bank_mask:0xf
    v_add_f32_dpp v69, v65, v65 row_ror:8 row_mask:0xf bank_mask:0xf
    v_add_f32_dpp v76, v72, v72 row_ror:8 row_mask:0xf bank_mask:0xf
    v_add_f32_dpp v77, v73, v73 row_ror:8 row_mask:0xf bank_mask:0xf
    v_and_b32 v6, 8, v3
    v_cmp_eq_u32 vcc, 0, v6
    s_nop 1
    v_cndmask_b32 v64, v69, v68, vcc
    v_cndmask_b32 v65, v77, v76, vcc
    v_lshrrev_b32 v6, 3, v3
    v_lshl_add_u32 v6, v10, 3, v6
    v_lshlrev_b32 v6, 3, v6
    s_lshl_b32 s31, s47, 9
    s_add_u32 s31, s31, 69632
    v_add_u32 v7, s31, v6
    ds_write_b64 v7, v[64:65]
    s_waitcnt lgkmcnt(0)
    s_barrier
    s_cmp_lg_u32 s47, 0
    s_cbranch_scc1 ffn_tail
    v_lshlrev_b32 v6, 3, v3
    v_add_u32 v7, 69632, v6
    ds_read_b64 v[64:65], v7 offset:0
    ds_read_b64 v[66:67], v7 offset:512
    ds_read_b64 v[68:69], v7 offset:1024
    ds_read_b64 v[70:71], v7 offset:1536
    ds_read_b64 v[72:73], v7 offset:2048
    ds_read_b64 v[74:75], v7 offset:2560
    ds_read_b64 v[76:77], v7 offset:3072
    ds_read_b64 v[78:79], v7 offset:3584
    s_waitcnt lgkmcnt(0)
    v_pk_add_f32 v[64:65], v[64:65], v[66:67]
    v_pk_add_f32 v[68:69], v[68:69], v[70:71]
    v_pk_add_f32 v[72:73], v[72:73], v[74:75]
    v_pk_add_f32 v[76:77], v[76:77], v[78:79]
    v_pk_add_f32 v[64:65], v[64:65], v[68:69]
    v_pk_add_f32 v[72:73], v[72:73], v[76:77]
    v_pk_add_f32 v[64:65], v[64:65], v[72:73]
    s_lshl_b32 s31, s29, 9
    buffer_atomic_add_f32 v64, v6, s[16:19], s31 offen
    buffer_atomic_add_f32 v65, v6, s[16:19], s31 offen offset:4
    s_branch ffn_tail
ffn_final:
    s_nop 3
    v_mul_u32_u24 v6, 144, v11
    v_lshl_add_u32 v6, v10, 4, v6
    v_add_u32 v6, 77824, v6
    ds_write_b128 v6, v[40:43]
    v_lshrrev_b32 v7, 2, v5
    v_lshl_add_u32 v7, v4, 3, v7
    v_mul_u32_u24 v7, 144, v7
    v_and_b32 v6, 3, v3
    v_lshl_add_u32 v7, v6, 3, v7
    s_and_b32 s30, s47, 1
    s_lshr_b32 s40, s47, 1
    s_mul_i32 s31, s30, 4608
    s_lshl_b32 s41, s40, 5
    s_add_u32 s31, s31, s41
    s_add_u32 s31, s31, 77824
    v_add_u32 v7, s31, v7
    s_waitcnt lgkmcnt(0)
    s_barrier
    ds_read_b64_tr_b16 v[32:33], v7
    ds_read_b64_tr_b16 v[34:35], v7 offset:576
    v_lshlrev_b32 v7, 10, v5
    v_lshl_add_u32 v7, v4, 4, v7
    s_lshl_b32 s31, s29, 16
    s_lshl_b32 s41, s26, 7
    s_add_u32 s31, s31, s41
    s_lshl_b32 s41, s40, 14
    s_add_u32 s31, s31, s41
    s_lshl_b32 s41, s30, 6
    s_add_u32 s31, s31, s41
    s_waitcnt lgkmcnt(0)
    buffer_store_dwordx4 v[32:35], v7, s[32:35], s31 offen sc1
ffn_tail:
ffn_done:
    s_endpgm
ffn_end:

.section .rodata,"a"
.p2align 6
.amdhsa_kernel front_kernel
  .amdhsa_next_free_vgpr 155
  .amdhsa_next_free_sgpr 68
  .amdhsa_accum_offset 156
  .amdhsa_group_segment_fixed_size 0
  .amdhsa_kernarg_size 128
  .amdhsa_user_sgpr_count 2
  .amdhsa_user_sgpr_kernarg_segment_ptr 1
  .amdhsa_system_sgpr_workgroup_id_x 1
.end_amdhsa_kernel

.p2align 6
.amdhsa_kernel conv2_kernel
  .amdhsa_next_free_vgpr 155
  .amdhsa_next_free_sgpr 48
  .amdhsa_accum_offset 156
  .amdhsa_group_segment_fixed_size 0
  .amdhsa_kernarg_size 128
  .amdhsa_user_sgpr_count 2
  .amdhsa_user_sgpr_kernarg_segment_ptr 1
  .amdhsa_system_sgpr_workgroup_id_x 1
.end_amdhsa_kernel

.p2align 6
.amdhsa_kernel ffn2_kernel
  .amdhsa_next_free_vgpr 216
  .amdhsa_next_free_sgpr 70
  .amdhsa_accum_offset 152
  .amdhsa_group_segment_fixed_size 0
  .amdhsa_kernarg_size 128
  .amdhsa_user_sgpr_count 2
  .amdhsa_user_sgpr_kernarg_segment_ptr 1
  .amdhsa_system_sgpr_workgroup_id_x 1
.end_amdhsa_kernel

.p2align 6
.amdhsa_kernel ffn1_kernel
  .amdhsa_next_free_vgpr 216
  .amdhsa_next_free_sgpr 70
  .amdhsa_accum_offset 152
  .amdhsa_group_segment_fixed_size 0
  .amdhsa_kernarg_size 128
  .amdhsa_user_sgpr_count 2
  .amdhsa_user_sgpr_kernarg_segment_ptr 1
  .amdhsa_system_sgpr_workgroup_id_x 1
.end_amdhsa_kernel
```
